```python
import torch

def _softmax(x, axis=-1):
    return torch.softmax(x, dim=axis)
def _gelu(x):
    return torch.nn.functional.gelu(x, approximate="tanh")
def _silu(x):
    return torch.nn.functional.silu(x)
def _sigmoid(x):
    return torch.sigmoid(x)
def _layernorm(x, axis=-1, eps=1e-5):
    m = x.mean(dim=axis, keepdim=True)
    v = x.var(dim=axis, keepdim=True, unbiased=False)
    return (x - m) / torch.sqrt(v + eps)
def _scatter_add(tgt, idx, src, axis=0):
    return tgt.clone().index_add_(axis, idx, src)
def _segment_sum(src, seg, n):
    out = torch.zeros((n,) + src.shape[1:], dtype=src.dtype)
    return out.index_add_(0, seg, src)
def _pad(x, pw):
    flat = tuple(v for pair in reversed(pw) for v in pair)
    return torch.nn.functional.pad(x, flat)

kernel_name = 'standalone__hybrid_graph_tf_exphormer__graph'

def setup_inputs():

    _w = (lambda a: (lambda t: t.to(torch.bfloat16) if t.is_floating_point() else t)(torch.as_tensor(a)))
    N, deg, D = 50000, 16, 64
    E = N * deg
    exp_deg = 4
    Ee = N * exp_deg
    src = (lambda lo, hi, *s: torch.randint(lo, hi, s))(0, N, E).to(torch.int64)
    dst = (lambda lo, hi, *s: torch.randint(lo, hi, s))(0, N, E).to(torch.int64)
    esrc = (lambda lo, hi, *s: torch.randint(lo, hi, s))(0, N, Ee).to(torch.int64)
    edst = torch.repeat_interleave(torch.arange(N), exp_deg).to(torch.int64)
    deg_cnt = torch.bincount(dst, minlength=N).to(float) + 1.0
    return {
        "x": _w((lambda *s: torch.randn(*s, dtype=torch.bfloat16) * 0.05)(N, D)),
        "src": _w(src),
        "dst": _w(dst),
        "esrc": _w(esrc),
        "edst": _w(edst),
        "deg_inv_sqrt": _w(1.0 / (lambda _x: torch.sqrt(torch.as_tensor(_x)))(deg_cnt)),
        "w_l": _w((lambda *s: torch.randn(*s, dtype=torch.bfloat16) * 0.05)(D, D)),
        "wq": _w((lambda *s: torch.randn(*s, dtype=torch.bfloat16) * 0.05)(D, D)),
        "wk": _w((lambda *s: torch.randn(*s, dtype=torch.bfloat16) * 0.05)(D, D)),
        "wv": _w((lambda *s: torch.randn(*s, dtype=torch.bfloat16) * 0.05)(D, D)),
    }

def reference(x, src, dst, esrc, edst, deg_inv_sqrt, w_l, wq, wk, wv):
    N, D = x.shape
    h = x @ w_l
    msg = h[src] * deg_inv_sqrt[src, None] * deg_inv_sqrt[dst, None]
    h_local = _segment_sum(msg, dst, N)
    q = x @ wq
    k = x @ wk
    v = x @ wv
    e = (q[edst] * k[esrc]).sum(-1) * (D ** -0.5)
    exp_e = torch.exp(e)
    denom = _segment_sum(exp_e[:, None], edst, N)[:, 0] + 1e-9
    alpha = exp_e / denom[edst]
    h_attn = _segment_sum(alpha[:, None] * v[esrc], edst, N)
    return h_local + h_attn
```

```asm
; @launch grid=(256,1,1) block=(1024,1,1) lds=163840
.amdgcn_target "amdgcn-amd-amdhsa--gfx950"
.text
.globl standalone__hybrid_graph_tf_exphormer__graph_kernel
.p2align 8
.type standalone__hybrid_graph_tf_exphormer__graph_kernel,@function
standalone__hybrid_graph_tf_exphormer__graph_kernel:
    s_cmp_ge_u32 s2, 256
    s_cbranch_scc1 K_END
    s_setprio 3
    s_load_dwordx16 s[4:19], s[0:1], 0
    s_load_dwordx8 s[20:27], s[0:1], 64
    s_load_dwordx2 s[28:29], s[0:1], 96
    v_readfirstlane_b32 s3, v0
    v_mov_b32 v15, 0
    v_lshlrev_b32 v10, 2, v0
    s_lshr_b32 s3, s3, 6
    v_and_b32 v1, 63, v0
    v_and_b32 v9, 3, v0
    v_lshlrev_b32 v2, 4, v9
    v_mov_b32 v12, 1
    v_mov_b32 v61, 0
    v_mov_b32 v62, 0
    s_cmp_ge_u32 s3, 13
    s_cbranch_scc1 K_H0
    s_mul_i32 s30, s2, 12500
    v_add_u32 v84, s30, v10
    v_add_u32 v85, 6656, v84
    s_mul_i32 s58, s2, 196
    s_lshl_b32 s30, s3, 4
    s_add_u32 s58, s58, s30
    v_lshl_add_u32 v8, s58, 2, v1
    v_min_u32 v8, 199999, v8
    v_lshlrev_b32 v8, 2, v8
    s_waitcnt lgkmcnt(0)
    global_load_dword v64, v84, s[8:9] offset:0
    global_load_dword v68, v84, s[6:7] offset:0
    global_load_dword v65, v84, s[8:9] offset:3328
    global_load_dword v69, v84, s[6:7] offset:3328
    global_load_dword v66, v85, s[8:9] offset:0
    global_load_dword v70, v85, s[6:7] offset:0
    v_cmpx_gt_u32 vcc, 629, v0
    s_mov_b64 s[60:61], exec
    s_cbranch_execz K_NO4
    global_load_dword v67, v85, s[8:9] offset:3328
    global_load_dword v71, v85, s[6:7] offset:3328
K_NO4:
    s_mov_b64 exec, -1
    global_load_dword v58, v8, s[10:11]
    v_lshlrev_b32 v11, 4, v0
    v_lshlrev_b32 v9, 2, v0
    v_mov_b32 v24, 0x00ffffff
    v_mov_b32 v25, v24
    v_mov_b32 v26, v24
    v_mov_b32 v27, v24
    ds_write_b128 v11, v[24:27] offset:0
    ds_write_b128 v11, v[24:27] offset:16384
    v_cmpx_gt_u32 vcc, 456, v0
    ds_write_b32 v9, v15 offset:60672
    v_cmpx_gt_u32 vcc, 256, v0
    ds_write_b128 v11, v[24:27] offset:32768
    ds_write_b32 v9, v15 offset:59648
    s_mov_b64 exec, -1
    s_waitcnt lgkmcnt(0)
    s_barrier
    v_lshrrev_b32 v26, 3, v0
    v_and_b32 v29, 3, v0
    v_mul_u32_u24 v28, 144, v26
    v_lshl_add_u32 v28, v29, 2, v28
    v_bfe_u32 v29, v0, 2, 1
    v_lshlrev_b32 v27, 6, v29
    v_add_u32 v28, v27, v28
    v_xor_b32 v27, 64, v27
    v_add_u32 v29, 18432, v28
    v_and_b32 v31, 7, v0
    v_lshlrev_b32 v30, 15, v26
    v_lshl_add_u32 v30, v31, 4, v30
    s_lshl_b32 s30, s2, 7
    s_add_u32 s30, s30, 65536
    v_add_u32 v30, s30, v30
    v_add_u32 v31, 4194304, v30
    v_lshlrev_b32 v26, 2, v26
    v_lshrrev_b32 v7, 2, v0
    v_lshl_add_u32 v7, v7, 7, v2
    s_lshl_b32 s30, s2, 15
    s_add_u32 s30, s30, 65536
    v_add_u32 v7, s30, v7
    s_mov_b32 s70, 85599
    s_mov_b32 s71, -196
    s_mov_b32 s32, s4
    s_mov_b32 s33, s5
    s_mov_b32 s34, 6400000
    s_mov_b32 s35, 0x20000
    s_waitcnt vmcnt(5)
    v_mul_u32_u24 v8, s70, v64
    v_lshrrev_b32 v72, 24, v8
    v_mad_i32_i24 v9, v72, s71, v64
    v_lshlrev_b32 v11, 2, v72
    ds_add_rtn_u32 v80, v11, v12 offset:60672
    v_lshl_or_b32 v76, v9, 16, v68
    s_waitcnt vmcnt(3)
    v_mul_u32_u24 v8, s70, v65
    v_lshrrev_b32 v73, 24, v8
    v_mad_i32_i24 v9, v73, s71, v65
    v_lshlrev_b32 v11, 2, v73
    ds_add_rtn_u32 v81, v11, v12 offset:60672
    v_lshl_or_b32 v77, v9, 16, v69
    s_waitcnt vmcnt(1)
    v_mul_u32_u24 v8, s70, v66
    v_lshrrev_b32 v74, 24, v8
    v_mad_i32_i24 v9, v74, s71, v66
    v_lshlrev_b32 v11, 2, v74
    ds_add_rtn_u32 v82, v11, v12 offset:60672
    v_lshl_or_b32 v78, v9, 16, v70
    s_mov_b64 exec, s[60:61]
    s_cbranch_execz K_F3
    v_mul_u32_u24 v8, s70, v67
    v_lshrrev_b32 v75, 24, v8
    v_mad_i32_i24 v9, v75, s71, v67
    v_lshlrev_b32 v11, 2, v75
    ds_add_rtn_u32 v83, v11, v12 offset:60672
    v_lshl_or_b32 v79, v9, 16, v71
K_F3:
    s_mov_b64 exec, -1
    s_waitcnt lgkmcnt(0)
    v_min_u32 v10, 32, v80
    v_mul_u32_u24 v11, 144, v72
    v_lshl_add_u32 v11, v10, 2, v11
    ds_write_b32 v11, v76 offset:0
    v_min_u32 v10, 32, v81
    v_mul_u32_u24 v11, 144, v73
    v_lshl_add_u32 v11, v10, 2, v11
    ds_write_b32 v11, v77 offset:0
    v_min_u32 v10, 32, v82
    v_mul_u32_u24 v11, 144, v74
    v_lshl_add_u32 v11, v10, 2, v11
    ds_write_b32 v11, v78 offset:0
    v_max3_u32 v8, v80, v81, v82
    s_mov_b64 exec, s[60:61]
    s_cbranch_execz K_B3
    v_min_u32 v10, 32, v83
    v_mul_u32_u24 v11, 144, v75
    v_lshl_add_u32 v11, v10, 2, v11
    ds_write_b32 v11, v79 offset:0
    v_max_u32 v8, v8, v83
K_B3:
    s_mov_b64 exec, -1
    v_cmp_le_u32 vcc, 32, v8
    s_cbranch_vccnz K_AOVF
K_AOVF_RET:
    s_branch K_BAR1
K_H0:
    s_waitcnt lgkmcnt(0)
    s_mov_b32 s32, s4
    s_mov_b32 s33, s5
    s_mov_b32 s34, 6400000
    s_mov_b32 s35, 0x20000
    s_mov_b32 s40, s14
    s_mov_b32 s41, s15
    s_mov_b32 s42, 100000
    s_mov_b32 s43, 0x20000
    v_lshlrev_b32 v59, 4, v1
    v_mov_b32 v58, 0
    v_lshlrev_b32 v11, 4, v0
    v_lshlrev_b32 v9, 2, v0
    v_mov_b32 v24, 0x00ffffff
    v_mov_b32 v25, v24
    v_mov_b32 v26, v24
    v_mov_b32 v27, v24
    ds_write_b128 v11, v[24:27] offset:0
    ds_write_b128 v11, v[24:27] offset:16384
    v_cmpx_gt_u32 vcc, 456, v0
    ds_write_b32 v9, v15 offset:60672
    v_cmpx_gt_u32 vcc, 256, v0
    ds_write_b128 v11, v[24:27] offset:32768
    ds_write_b32 v9, v15 offset:59648
    s_mov_b64 exec, -1
    s_waitcnt lgkmcnt(0)
    s_barrier
    v_lshrrev_b32 v26, 3, v0
    v_and_b32 v29, 3, v0
    v_mul_u32_u24 v28, 144, v26
    v_lshl_add_u32 v28, v29, 2, v28
    v_bfe_u32 v29, v0, 2, 1
    v_lshlrev_b32 v27, 6, v29
    v_add_u32 v28, v27, v28
    v_xor_b32 v27, 64, v27
    v_add_u32 v29, 18432, v28
    v_and_b32 v31, 7, v0
    v_lshlrev_b32 v30, 15, v26
    v_lshl_add_u32 v30, v31, 4, v30
    s_lshl_b32 s30, s2, 7
    s_add_u32 s30, s30, 65536
    v_add_u32 v30, s30, v30
    v_add_u32 v31, 4194304, v30
    v_lshlrev_b32 v26, 2, v26
    v_lshrrev_b32 v7, 2, v0
    v_lshl_add_u32 v7, v7, 7, v2
    s_lshl_b32 s30, s2, 15
    s_add_u32 s30, s30, 65536
    v_add_u32 v7, s30, v7
    s_cmp_eq_u32 s3, 15
    s_cbranch_scc1 K_H15A
    s_setprio 0
    s_lshr_b32 s62, s2, 3
    s_mul_i32 s62, s62, 3
    s_add_u32 s62, s62, s3
    s_add_u32 s62, s62, 85
    s_mul_hi_u32 s63, s62, 43826197
    s_mul_i32 s63, s63, 98
    s_sub_u32 s62, s62, s63
    s_lshl_b32 s62, s62, 10
    s_mov_b32 s63, 18
K_DMA1:
    s_add_u32 m0, s62, 63488
    s_sub_u32 s63, s63, 1
    buffer_load_dwordx4 v59, s[40:43], s62 offen lds
    s_add_u32 s62, s62, 2048
    s_cmp_ge_u32 s62, 100352
    s_cselect_b32 s64, 100352, 0
    s_sub_u32 s62, s62, s64
    s_cmp_lg_u32 s63, 0
    s_cbranch_scc1 K_DMA1
    s_branch K_H0X
K_H15A:
    global_load_dword v60, v15, s[28:29] sc1
    s_mul_i32 s30, s2, 196
    v_add_u32 v8, s30, v1
    v_min_u32 v8, 49999, v8
    v_lshlrev_b32 v8, 1, v8
    global_load_ushort v32, v8, s[14:15]
    v_add_u32 v8, s30, v1
    v_add_u32 v8, 64, v8
    v_min_u32 v8, 49999, v8
    v_lshlrev_b32 v8, 1, v8
    global_load_ushort v33, v8, s[14:15]
    v_add_u32 v8, s30, v1
    v_add_u32 v8, 128, v8
    v_min_u32 v8, 49999, v8
    v_lshlrev_b32 v8, 1, v8
    global_load_ushort v34, v8, s[14:15]
    v_add_u32 v8, s30, v1
    v_add_u32 v8, 192, v8
    v_min_u32 v8, 49999, v8
    v_lshlrev_b32 v8, 1, v8
    global_load_ushort v35, v8, s[14:15]
    s_setprio 1
    v_lshlrev_b32 v11, 4, v1
    global_load_dwordx4 v[64:67], v11, s[18:19] offset:0
    global_load_dwordx4 v[68:71], v11, s[18:19] offset:1024
    global_load_dwordx4 v[72:75], v11, s[18:19] offset:2048
    global_load_dwordx4 v[76:79], v11, s[18:19] offset:3072
    v_add_u32 v11, 0x1000, v11
    global_load_dwordx4 v[80:83], v11, s[18:19] offset:0
    global_load_dwordx4 v[84:87], v11, s[18:19] offset:1024
    global_load_dwordx4 v[88:91], v11, s[18:19] offset:2048
    global_load_dwordx4 v[92:95], v11, s[18:19] offset:3072
    v_add_u32 v11, 0xfffff000, v11
    global_load_dwordx4 v[96:99], v11, s[20:21] offset:0
    global_load_dwordx4 v[100:103], v11, s[20:21] offset:1024
    global_load_dwordx4 v[104:107], v11, s[20:21] offset:2048
    global_load_dwordx4 v[108:111], v11, s[20:21] offset:3072
    v_add_u32 v11, 0x1000, v11
    global_load_dwordx4 v[112:115], v11, s[20:21] offset:0
    global_load_dwordx4 v[116:119], v11, s[20:21] offset:1024
    global_load_dwordx4 v[120:123], v11, s[20:21] offset:2048
    global_load_dwordx4 v[124:127], v11, s[20:21] offset:3072
    s_setprio 3
    s_waitcnt vmcnt(16)
    v_add_u32 v60, 0x02000000, v60
    v_and_b32 v60, 0xfe000000, v60
    ds_write_b32 v15, v60 offset:61700
K_H0X:
    s_setprio 3
K_BAR1:
    s_waitcnt lgkmcnt(0)
    s_barrier
    ds_read2_b32 v[44:45], v28 offset0:0 offset1:4
    ds_read2_b32 v[46:47], v28 offset0:8 offset1:12
    ds_read2_b32 v[48:49], v29 offset0:0 offset1:4
    ds_read2_b32 v[50:51], v29 offset0:8 offset1:12
    ds_read_b64 v[52:53], v15 offset:61696
    ds_read_b32 v54, v26 offset:60672
    ds_read_b32 v55, v26 offset:61184
    s_waitcnt lgkmcnt(0)
    v_readfirstlane_b32 s30, v52
    v_readfirstlane_b32 s48, v53
    v_or_b32 v44, v53, v44
    v_or_b32 v45, v53, v45
    v_or_b32 v46, v53, v46
    v_or_b32 v47, v53, v47
    s_cmp_lg_u32 s30, 0
    s_cbranch_scc1 K_AOVF2
    v_bfe_u32 v9, v53, 25, 6
    v_cmp_eq_u32 vcc, 0, v9
    v_mov_b32 v9, 64
    s_nop 0
    v_cndmask_b32 v27, v27, v9, vcc
    v_add_u32 v54, v54, v27
    v_add_u32 v55, v55, v27
    v_cmpx_le_u32 vcc, 16, v54
    global_store_dwordx4 v30, v[44:47], s[28:29] sc1
    s_mov_b64 exec, -1
    v_or_b32 v48, v53, v48
    v_or_b32 v49, v53, v49
    v_or_b32 v50, v53, v50
    v_or_b32 v51, v53, v51
    v_cmpx_le_u32 vcc, 16, v55
K_AOVF2_RET:
    global_store_dwordx4 v31, v[48:51], s[28:29] sc1
    s_mov_b64 exec, -1
    s_lshr_b32 s49, s48, 24
    s_cmp_ge_u32 s3, 13
    s_cbranch_scc1 K_H2
    s_setprio 0
    s_waitcnt vmcnt(2)
    s_lshl_b32 s30, s3, 4
    v_lshrrev_b32 v8, 2, v1
    v_add_u32 v8, s30, v8
    s_mul_i32 s30, s2, 196
    s_sub_u32 s30, 50000, s30
    s_min_u32 s30, s30, 196
    v_cmp_gt_u32 vcc, s30, v8
    v_mov_b32 v9, 50000
    s_nop 0
    v_cndmask_b32 v58, v9, v58, vcc
    s_nop 1
    v_mov_b32_dpp v60, v58 quad_perm:[0,0,0,0] row_mask:0xf bank_mask:0xf
    v_mov_b32_dpp v61, v58 quad_perm:[1,1,1,1] row_mask:0xf bank_mask:0xf
    v_mov_b32_dpp v62, v58 quad_perm:[2,2,2,2] row_mask:0xf bank_mask:0xf
    v_mov_b32_dpp v63, v58 quad_perm:[3,3,3,3] row_mask:0xf bank_mask:0xf
    s_mov_b32 s40, s14
    s_mov_b32 s41, s15
    s_mov_b32 s42, 100000
    s_mov_b32 s43, 0x20000
    v_lshlrev_b32 v59, 4, v1
    s_lshr_b32 s62, s2, 3
    s_mul_i32 s62, s62, 3
    s_mul_i32 s30, s3, 5
    s_add_u32 s62, s62, s30
    s_add_u32 s62, s62, 36
    s_mul_hi_u32 s63, s62, 43826197
    s_mul_i32 s63, s63, 98
    s_sub_u32 s62, s62, s63
    s_lshl_b32 s62, s62, 10
    s_mov_b32 s63, 5
K_DMA2:
    s_add_u32 m0, s62, 63488
    s_sub_u32 s63, s63, 1
    buffer_load_dwordx4 v59, s[40:43], s62 offen lds
    s_add_u32 s62, s62, 1024
    s_cmp_ge_u32 s62, 100352
    s_cselect_b32 s64, 100352, 0
    s_sub_u32 s62, s62, s64
    s_cmp_lg_u32 s63, 0
    s_cbranch_scc1 K_DMA2
    s_setprio 3
    s_barrier
    s_lshl_b32 s30, s3, 4
    v_lshrrev_b32 v11, 2, v1
    v_add_u32 v8, s30, v11
    s_cmp_eq_u32 s3, 0
    s_cselect_b32 s30, 1, 0
    s_cselect_b32 s31, 0, 8
    v_lshrrev_b32 v13, s30, v8
    v_subrev_u32 v13, s31, v13
    v_min_u32 v14, 196, v8
    v_and_b32 v9, 15, v0
    v_lshrrev_b32 v10, 4, v1
    v_lshl_add_u32 v3, v9, 2, v10
    v_lshlrev_b32 v3, 2, v3
    v_and_b32 v8, 3, v0
    v_lshl_add_u32 v4, v8, 4, v11
    v_lshlrev_b32 v4, 2, v4
    v_lshrrev_b32 v10, 4, v1
    v_bfe_u32 v5, v1, 2, 2
    v_lshl_add_u32 v5, v10, 3, v5
    v_mul_u32_u24 v5, 144, v5
    v_add_u32 v5, v5, v2
    v_mov_b32 v57, 50000
    s_waitcnt vmcnt(5)
    s_setprio 3
    global_load_dwordx4 v[16:19], v7, s[28:29] sc1
    global_load_dwordx4 v[20:23], v7, s[28:29] offset:64 sc1
    s_setprio 3
    s_waitcnt vmcnt(0)
    s_branch K_POLL
K_H2:
    s_cmp_lg_u32 s3, 15
    s_cbranch_scc1 K_H2B
    s_waitcnt vmcnt(2)
    v_lshrrev_b32 v8, 3, v1
    v_mul_u32_u24 v8, 144, v8
    v_and_b32 v9, 7, v1
    v_lshl_add_u32 v8, v9, 4, v8
    ds_write_b128 v8, v[64:67] offset:41216
    ds_write_b128 v8, v[68:71] offset:42368
    ds_write_b128 v8, v[72:75] offset:43520
    ds_write_b128 v8, v[76:79] offset:44672
    ds_write_b128 v8, v[80:83] offset:45824
    ds_write_b128 v8, v[84:87] offset:46976
    ds_write_b128 v8, v[88:91] offset:48128
    ds_write_b128 v8, v[92:95] offset:49280
    ds_write_b128 v8, v[96:99] offset:50432
    ds_write_b128 v8, v[100:103] offset:51584
    ds_write_b128 v8, v[104:107] offset:52736
    ds_write_b128 v8, v[108:111] offset:53888
    ds_write_b128 v8, v[112:115] offset:55040
    ds_write_b128 v8, v[116:119] offset:56192
    ds_write_b128 v8, v[120:123] offset:57344
    ds_write_b128 v8, v[124:127] offset:58496
    s_waitcnt lgkmcnt(0)
K_H2B:
    s_barrier
    v_mov_b32 v13, 196
    v_mov_b32 v14, 196
    s_waitcnt vmcnt(0)
    s_setprio 3
    global_load_dwordx4 v[16:19], v7, s[28:29] sc1
    global_load_dwordx4 v[20:23], v7, s[28:29] offset:64 sc1
    s_cmp_lg_u32 s3, 15
    s_cbranch_scc1 K_NOSORT
    v_lshlrev_b32 v36, 16, v32
    v_lshlrev_b32 v37, 16, v33
    v_lshlrev_b32 v38, 16, v34
    v_lshlrev_b32 v39, 16, v35
    v_mul_f32 v36, v36, v36
    v_mul_f32 v37, v37, v37
    v_mul_f32 v38, v38, v38
    v_mul_f32 v39, v39, v39
    v_rcp_f32 v36, v36
    v_rcp_f32 v37, v37
    v_rcp_f32 v38, v38
    v_rcp_f32 v39, v39
    s_nop 0
    v_min_f32 v36, 0x427c0000, v36
    v_min_f32 v37, 0x427c0000, v37
    v_min_f32 v38, 0x427c0000, v38
    v_min_f32 v39, 0x427c0000, v39
    v_cvt_u32_f32 v36, v36
    v_cvt_u32_f32 v37, v37
    v_cvt_u32_f32 v38, v38
    v_cvt_u32_f32 v39, v39
    v_sub_u32 v36, 63, v36
    v_lshlrev_b32 v36, 2, v36
    v_sub_u32 v37, 63, v37
    v_lshlrev_b32 v37, 2, v37
    v_sub_u32 v38, 63, v38
    v_lshlrev_b32 v38, 2, v38
    v_sub_u32 v39, 63, v39
    v_lshlrev_b32 v39, 2, v39
    ds_add_rtn_u32 v40, v36, v12 offset:61712
    ds_add_rtn_u32 v41, v37, v12 offset:61712
    ds_add_rtn_u32 v42, v38, v12 offset:61712
    v_cmpx_gt_u32 vcc, 4, v1
    ds_add_rtn_u32 v43, v39, v12 offset:61712
    s_mov_b64 exec, -1
    v_lshlrev_b32 v8, 2, v1
    ds_read_b32 v9, v8 offset:61712
    s_waitcnt lgkmcnt(0)
    v_mov_b32 v10, v9
    s_nop 1
    v_add_u32_dpp v10, v10, v10 row_shr:1 row_mask:0xf bank_mask:0xf
    s_nop 1
    v_add_u32_dpp v10, v10, v10 row_shr:2 row_mask:0xf bank_mask:0xf
    s_nop 1
    v_add_u32_dpp v10, v10, v10 row_shr:4 row_mask:0xf bank_mask:0xf
    s_nop 1
    v_add_u32_dpp v10, v10, v10 row_shr:8 row_mask:0xf bank_mask:0xf
    s_nop 1
    v_add_u32_dpp v10, v10, v10 row_bcast:15 row_mask:0xa bank_mask:0xf
    s_nop 1
    v_add_u32_dpp v10, v10, v10 row_bcast:31 row_mask:0xc bank_mask:0xf
    v_sub_u32 v10, v10, v9
    ds_bpermute_b32 v36, v36, v10
    ds_bpermute_b32 v37, v37, v10
    ds_bpermute_b32 v38, v38, v10
    ds_bpermute_b32 v39, v39, v10
    v_add_u32 v8, 196, v1
    v_mov_b32 v9, 196
    v_cmpx_gt_u32 vcc, 12, v1
    ds_write_b8 v8, v9 offset:62224
    s_mov_b64 exec, -1
    s_waitcnt lgkmcnt(0)
    v_add_u32 v36, v36, v40
    v_add_u32 v40, 0, v1
    v_add_u32 v37, v37, v41
    v_add_u32 v41, 64, v1
    v_add_u32 v38, v38, v42
    v_add_u32 v42, 128, v1
    v_add_u32 v39, v39, v43
    v_add_u32 v43, 192, v1
    ds_write_b8 v36, v40 offset:62224
    ds_write_b8 v37, v41 offset:62224
    ds_write_b8 v38, v42 offset:62224
    v_cmpx_gt_u32 vcc, 4, v1
    ds_write_b8 v39, v43 offset:62224
    s_mov_b64 exec, -1
    s_waitcnt lgkmcnt(0)
    v_cmpx_eq_u32 vcc, 0, v1
    ds_add_u32 v15, v12 offset:62492
    s_mov_b64 exec, -1
K_NOSORT:
    v_lshrrev_b32 v10, 4, v1
    v_bfe_u32 v5, v1, 2, 2
    v_lshl_add_u32 v5, v10, 3, v5
    v_mul_u32_u24 v5, 144, v5
    v_add_u32 v5, v5, v2
    v_and_b32 v9, 15, v0
    v_lshrrev_b32 v6, 2, v9
    v_lshlrev_b32 v6, 3, v6
    v_and_b32 v8, 3, v9
    v_add_u32 v6, v6, v8
    v_mul_u32_u24 v6, 144, v6
    v_lshl_add_u32 v6, v10, 4, v6
    ds_read_b64_tr_b16 v[64:65], v5 offset:41216
    ds_read_b64_tr_b16 v[66:67], v5 offset:41792
    ds_read_b64_tr_b16 v[68:69], v5 offset:45824
    ds_read_b64_tr_b16 v[70:71], v5 offset:46400
    ds_read_b64_tr_b16 v[72:73], v5 offset:41224
    ds_read_b64_tr_b16 v[74:75], v5 offset:41800
    ds_read_b64_tr_b16 v[76:77], v5 offset:45832
    ds_read_b64_tr_b16 v[78:79], v5 offset:46408
    ds_read_b64_tr_b16 v[80:81], v5 offset:41280
    ds_read_b64_tr_b16 v[82:83], v5 offset:41856
    ds_read_b64_tr_b16 v[84:85], v5 offset:45888
    ds_read_b64_tr_b16 v[86:87], v5 offset:46464
    ds_read_b64_tr_b16 v[88:89], v5 offset:41288
    ds_read_b64_tr_b16 v[90:91], v5 offset:41864
    ds_read_b64_tr_b16 v[92:93], v5 offset:45896
    ds_read_b64_tr_b16 v[94:95], v5 offset:46472
    ds_read_b128 v[96:99], v6 offset:50432
    ds_read_b128 v[100:103], v6 offset:50496
    ds_read_b128 v[104:107], v6 offset:51008
    ds_read_b128 v[108:111], v6 offset:51072
    ds_read_b128 v[112:115], v6 offset:55040
    ds_read_b128 v[116:119], v6 offset:55104
    ds_read_b128 v[120:123], v6 offset:55616
    ds_read_b128 v[124:127], v6 offset:55680
    s_waitcnt vmcnt(0)
    s_setprio 3
K_POLL:
    s_mov_b32 s56, 0
    s_mov_b32 s57, 0
    s_mov_b32 s55, 0
    v_mov_b32 v10, s48
    v_mov_b32_dpp v8, v19 quad_perm:[3,3,3,3] row_mask:0xf bank_mask:0xf
    v_mov_b32 v11, 50000
    v_or_b32 v9, 0x00ffffff, v10
    v_cmp_gt_u32_sdwa vcc, v11, v8 src0_sel:DWORD src1_sel:WORD_0
    s_nop 1
    v_cndmask_b32 v20, v9, v20, vcc
    v_cndmask_b32 v21, v9, v21, vcc
    v_cndmask_b32 v22, v9, v22, vcc
    v_cndmask_b32 v23, v9, v23, vcc
    v_cmpx_eq_u32_sdwa vcc, v16, s49 src0_sel:BYTE_3 src1_sel:DWORD
    v_cmpx_eq_u32_sdwa vcc, v17, s49 src0_sel:BYTE_3 src1_sel:DWORD
    v_cmpx_eq_u32_sdwa vcc, v18, s49 src0_sel:BYTE_3 src1_sel:DWORD
    v_cmpx_eq_u32_sdwa vcc, v19, s49 src0_sel:BYTE_3 src1_sel:DWORD
    v_cmpx_eq_u32_sdwa vcc, v20, s49 src0_sel:BYTE_3 src1_sel:DWORD
    v_cmpx_eq_u32_sdwa vcc, v21, s49 src0_sel:BYTE_3 src1_sel:DWORD
    v_cmpx_eq_u32_sdwa vcc, v22, s49 src0_sel:BYTE_3 src1_sel:DWORD
    v_cmpx_eq_u32_sdwa vcc, v23, s49 src0_sel:BYTE_3 src1_sel:DWORD
    s_cmp_eq_u64 exec, -1
    s_mov_b64 exec, -1
    s_cbranch_scc0 K_POLLSLOW
K_BUILD:
    s_cmp_ge_u32 s3, 13
    s_cbranch_scc1 K_NOGC
    s_setprio 0
    v_lshl_add_u32 v10, v60, 7, v2
    buffer_load_dwordx4 v[96:99], v10, s[32:35], 0 offen
    buffer_load_dwordx4 v[100:103], v10, s[32:35], 0 offen offset:64
    s_setprio 3
K_NOGC:
    v_mov_b32 v11, 50000
    v_lshlrev_b32_sdwa v32, 2, v16 dst_sel:DWORD dst_unused:UNUSED_PAD src0_sel:DWORD src1_sel:BYTE_2
    v_lshlrev_b32_sdwa v33, 2, v17 dst_sel:DWORD dst_unused:UNUSED_PAD src0_sel:DWORD src1_sel:BYTE_2
    v_lshlrev_b32_sdwa v34, 2, v18 dst_sel:DWORD dst_unused:UNUSED_PAD src0_sel:DWORD src1_sel:BYTE_2
    v_mov_b32 v42, 0
    v_lshlrev_b32_sdwa v35, 2, v19 dst_sel:DWORD dst_unused:UNUSED_PAD src0_sel:DWORD src1_sel:BYTE_2
    v_mov_b32 v43, 0
    v_lshlrev_b32_sdwa v36, 2, v20 dst_sel:DWORD dst_unused:UNUSED_PAD src0_sel:DWORD src1_sel:BYTE_2
    v_mov_b32 v44, 0
    v_lshlrev_b32_sdwa v37, 2, v21 dst_sel:DWORD dst_unused:UNUSED_PAD src0_sel:DWORD src1_sel:BYTE_2
    v_mov_b32 v45, 0
    v_lshlrev_b32_sdwa v38, 2, v22 dst_sel:DWORD dst_unused:UNUSED_PAD src0_sel:DWORD src1_sel:BYTE_2
    v_mov_b32 v46, 0
    v_lshlrev_b32_sdwa v39, 2, v23 dst_sel:DWORD dst_unused:UNUSED_PAD src0_sel:DWORD src1_sel:BYTE_2
    v_mov_b32 v47, 0
    v_mov_b32 v40, 0
    v_mov_b32 v41, 0
    v_cmpx_gt_u32_sdwa vcc, v11, v16 src0_sel:DWORD src1_sel:WORD_0
    ds_add_rtn_u32 v40, v32, v12 offset:59648
    v_cmpx_gt_u32_sdwa vcc, v11, v17 src0_sel:DWORD src1_sel:WORD_0
    ds_add_rtn_u32 v41, v33, v12 offset:59648
    v_cmpx_gt_u32_sdwa vcc, v11, v18 src0_sel:DWORD src1_sel:WORD_0
    ds_add_rtn_u32 v42, v34, v12 offset:59648
    v_cmpx_gt_u32_sdwa vcc, v11, v19 src0_sel:DWORD src1_sel:WORD_0
    s_cbranch_execz K_B0_A
    ds_add_rtn_u32 v43, v35, v12 offset:59648
    v_cmpx_gt_u32_sdwa vcc, v11, v20 src0_sel:DWORD src1_sel:WORD_0
    s_cbranch_execz K_B0_A
    ds_add_rtn_u32 v44, v36, v12 offset:59648
    v_cmpx_gt_u32_sdwa vcc, v11, v21 src0_sel:DWORD src1_sel:WORD_0
    s_cbranch_execz K_B0_A
    ds_add_rtn_u32 v45, v37, v12 offset:59648
    v_cmpx_gt_u32_sdwa vcc, v11, v22 src0_sel:DWORD src1_sel:WORD_0
    s_cbranch_execz K_B0_A
    ds_add_rtn_u32 v46, v38, v12 offset:59648
    v_cmpx_gt_u32_sdwa vcc, v11, v23 src0_sel:DWORD src1_sel:WORD_0
    s_cbranch_execz K_B0_A
    ds_add_rtn_u32 v47, v39, v12 offset:59648
K_B0_A:
    s_mov_b64 exec, -1
    s_waitcnt lgkmcnt(0)
    v_cmpx_gt_u32_sdwa vcc, v11, v16 src0_sel:DWORD src1_sel:WORD_0
    v_min_u32 v9, 39, v40
    v_lshlrev_b32 v9, 1, v9
    v_mad_u32_u24 v9, v32, 20, v9
    ds_write_b16 v9, v16 offset:0
    v_cmpx_gt_u32_sdwa vcc, v11, v17 src0_sel:DWORD src1_sel:WORD_0
    v_min_u32 v9, 39, v41
    v_lshlrev_b32 v9, 1, v9
    v_mad_u32_u24 v9, v33, 20, v9
    ds_write_b16 v9, v17 offset:0
    v_cmpx_gt_u32_sdwa vcc, v11, v18 src0_sel:DWORD src1_sel:WORD_0
    v_min_u32 v9, 39, v42
    v_lshlrev_b32 v9, 1, v9
    v_mad_u32_u24 v9, v34, 20, v9
    ds_write_b16 v9, v18 offset:0
    v_cmpx_gt_u32_sdwa vcc, v11, v19 src0_sel:DWORD src1_sel:WORD_0
    s_cbranch_execz K_B0_B
    v_min_u32 v9, 39, v43
    v_lshlrev_b32 v9, 1, v9
    v_mad_u32_u24 v9, v35, 20, v9
    ds_write_b16 v9, v19 offset:0
    v_cmpx_gt_u32_sdwa vcc, v11, v20 src0_sel:DWORD src1_sel:WORD_0
    s_cbranch_execz K_B0_B
    v_min_u32 v9, 39, v44
    v_lshlrev_b32 v9, 1, v9
    v_mad_u32_u24 v9, v36, 20, v9
    ds_write_b16 v9, v20 offset:0
    v_cmpx_gt_u32_sdwa vcc, v11, v21 src0_sel:DWORD src1_sel:WORD_0
    s_cbranch_execz K_B0_B
    v_min_u32 v9, 39, v45
    v_lshlrev_b32 v9, 1, v9
    v_mad_u32_u24 v9, v37, 20, v9
    ds_write_b16 v9, v21 offset:0
    v_cmpx_gt_u32_sdwa vcc, v11, v22 src0_sel:DWORD src1_sel:WORD_0
    s_cbranch_execz K_B0_B
    v_min_u32 v9, 39, v46
    v_lshlrev_b32 v9, 1, v9
    v_mad_u32_u24 v9, v38, 20, v9
    ds_write_b16 v9, v22 offset:0
    v_cmpx_gt_u32_sdwa vcc, v11, v23 src0_sel:DWORD src1_sel:WORD_0
    s_cbranch_execz K_B0_B
    v_min_u32 v9, 39, v47
    v_lshlrev_b32 v9, 1, v9
    v_mad_u32_u24 v9, v39, 20, v9
    ds_write_b16 v9, v23 offset:0
K_B0_B:
    s_mov_b64 exec, -1
    s_cmp_ge_u32 s3, 13
    s_cbranch_scc1 K_NOGE
    s_setprio 0
    v_lshl_add_u32 v10, v61, 7, v2
    buffer_load_dwordx4 v[104:107], v10, s[32:35], 0 offen
    buffer_load_dwordx4 v[108:111], v10, s[32:35], 0 offen offset:64
    s_setprio 3
K_NOGE:
    ds_read_b32 v30, v15 offset:62492
    ds_read_u8 v31, v13 offset:62224
    v_max3_u32 v8, v40, v41, v42
    v_max3_u32 v9, v43, v44, v45
    v_max3_u32 v8, v8, v46, v47
    v_max_u32 v8, v8, v9
    v_cmp_le_u32 vcc, 39, v8
    s_cbranch_vccnz K_PEND0
    s_cmp_lg_u32 s55, 0
    s_cbranch_scc1 K_SETFLAG0
K_FLAG_RET0:
    s_waitcnt lgkmcnt(0)
    s_barrier
    v_readfirstlane_b32 s30, v30
    s_cmp_ge_u32 s3, 13
    s_cbranch_scc1 K_PERMX
    s_cmp_lg_u32 s30, 0
    s_cbranch_scc1 K_PERMOK
    ds_read_u8 v31, v13 offset:62224
    s_waitcnt lgkmcnt(0)
K_PERMOK:
    v_mov_b32 v13, v31
K_PERMX:
    s_cmp_lg_u32 s2, 0
    s_cbranch_scc1 K_MAIN
    s_cmp_lg_u32 s3, 15
    s_cbranch_scc1 K_MAIN
    v_mov_b32 v8, s48
    global_store_dword v15, v8, s[28:29] sc1
K_MAIN:
    ds_read_b32 v8, v15 offset:60668
    s_cmp_ge_u32 s3, 13
    s_cbranch_scc1 K_NOCNT
    v_lshlrev_b32 v9, 2, v13
    v_mul_u32_u24 v7, 80, v13
    ds_read_b32 v56, v9 offset:59648
    ds_read_u16 v24, v7 offset:0
    ds_read_u16 v25, v7 offset:2
    ds_read_u16 v26, v7 offset:4
    ds_read_u16 v27, v7 offset:6
    ds_read_u16 v28, v7 offset:8
    ds_read_u16 v29, v7 offset:10
    ds_read_u16 v30, v7 offset:12
    ds_read_u16 v31, v7 offset:14
    s_cmp_lg_u32 s56, 0
    s_cbranch_scc1 K_NOCNT
    s_setprio 1
    v_lshl_add_u32 v10, v62, 7, v2
    buffer_load_dwordx4 v[112:115], v10, s[32:35], 0 offen
    buffer_load_dwordx4 v[116:119], v10, s[32:35], 0 offen offset:64
    v_lshl_add_u32 v10, v63, 7, v2
    buffer_load_dwordx4 v[120:123], v10, s[32:35], 0 offen
    buffer_load_dwordx4 v[124:127], v10, s[32:35], 0 offen offset:64
K_NOCNT:
    s_waitcnt lgkmcnt(0)
    v_readfirstlane_b32 s55, v8
    v_min_u32 v56, 39, v56
    s_and_b32 s30, s55, 1
    s_cbranch_scc1 K_SPILL
K_SPILL_RET:
    s_cmp_ge_u32 s3, 13
    s_cbranch_scc1 K_HMAIN
    s_cmp_lg_u32 s3, 0
    s_cbranch_scc1 K_NOSPLIT
    v_bfe_u32 v8, v1, 2, 1
    v_add_u32 v9, 1, v56
    v_cmp_eq_u32 vcc, 1, v8
    v_lshrrev_b32 v9, 1, v9
    v_sub_u32 v11, v56, v9
    v_cndmask_b32 v10, 0, v9, vcc
    v_cndmask_b32 v56, v9, v11, vcc
    v_lshl_add_u32 v7, v10, 1, v7
    ds_read_u16 v24, v7 offset:0
    ds_read_u16 v25, v7 offset:2
    ds_read_u16 v26, v7 offset:4
    ds_read_u16 v27, v7 offset:6
    ds_read_u16 v28, v7 offset:8
    ds_read_u16 v29, v7 offset:10
    ds_read_u16 v30, v7 offset:12
    ds_read_u16 v31, v7 offset:14
    s_waitcnt lgkmcnt(0)
K_NOSPLIT:
    s_mov_b32 s53, 0
    v_cmp_lt_u32 vcc, s53, v56
    s_add_u32 s53, s53, 1
    s_nop 0
    v_cndmask_b32 v24, v57, v24, vcc
    v_lshl_add_u32 v10, v24, 7, v2
    buffer_load_dwordx4 v[64:67], v10, s[32:35], 0 offen
    buffer_load_dwordx4 v[68:71], v10, s[32:35], 0 offen offset:64
    v_lshlrev_b32 v9, 1, v24
    ds_read_u16 v48, v9 offset:63488
    ds_read_u16 v24, v7 offset:16
    v_cmp_lt_u32 vcc, s53, v56
    s_add_u32 s53, s53, 1
    s_nop 0
    v_cndmask_b32 v25, v57, v25, vcc
    v_lshl_add_u32 v10, v25, 7, v2
    buffer_load_dwordx4 v[72:75], v10, s[32:35], 0 offen
    buffer_load_dwordx4 v[76:79], v10, s[32:35], 0 offen offset:64
    v_lshlrev_b32 v9, 1, v25
    ds_read_u16 v49, v9 offset:63488
    ds_read_u16 v25, v7 offset:18
    v_cmp_lt_u32 vcc, s53, v56
    s_add_u32 s53, s53, 1
    s_nop 0
    v_cndmask_b32 v26, v57, v26, vcc
    v_lshl_add_u32 v10, v26, 7, v2
    buffer_load_dwordx4 v[80:83], v10, s[32:35], 0 offen
    buffer_load_dwordx4 v[84:87], v10, s[32:35], 0 offen offset:64
    v_lshlrev_b32 v9, 1, v26
    ds_read_u16 v50, v9 offset:63488
    ds_read_u16 v26, v7 offset:20
    v_cmp_lt_u32 vcc, s53, v56
    s_add_u32 s53, s53, 1
    s_nop 0
    v_cndmask_b32 v27, v57, v27, vcc
    v_lshl_add_u32 v10, v27, 7, v2
    buffer_load_dwordx4 v[88:91], v10, s[32:35], 0 offen
    buffer_load_dwordx4 v[92:95], v10, s[32:35], 0 offen offset:64
    v_lshlrev_b32 v9, 1, v27
    ds_read_u16 v51, v9 offset:63488
    ds_read_u16 v27, v7 offset:22
    v_mov_b32 v9, v56
    v_and_b32 v6, 7, v14
    v_lshlrev_b32 v6, 4, v6
    v_max_u32_dpp v9, v9, v9 row_shr:4 row_mask:0xf bank_mask:0xf
    v_xor_b32 v6, v6, v2
    v_lshl_add_u32 v6, v14, 7, v6
    v_max_u32_dpp v9, v9, v9 row_shr:8 row_mask:0xf bank_mask:0xf
    s_lshl_b32 s30, s3, 2
    v_mov_b32 v8, s30
    v_max_u32_dpp v9, v9, v9 row_bcast:15 row_mask:0xa bank_mask:0xf
    s_nop 1
    v_max_u32_dpp v9, v9, v9 row_bcast:31 row_mask:0xc bank_mask:0xf
    s_nop 0
    v_readlane_b32 s52, v9, 63
    s_cmp_lg_u32 s56, 0
    s_cbranch_scc1 K_NOATT
    s_mov_b32 s62, 0
K_QW:
    ds_read_b32 v11, v8 offset:62432
    s_add_u32 s62, s62, 1
    s_waitcnt lgkmcnt(0)
    v_readfirstlane_b32 s63, v11
    s_cmp_ge_u32 s62, 200000
    s_cbranch_scc1 K_QW_X
    s_cmp_lt_u32 s63, 1
    s_cbranch_scc1 K_QW
K_QW_X:
    v_xor_b32 v11, 64, v6
    ds_read_b128 v[32:35], v6 offset:15872
    ds_read_b128 v[36:39], v11 offset:15872
    s_waitcnt vmcnt(8) lgkmcnt(0)
    v_dot2_f32_bf16 v52, v96, v32, 0
    v_dot2_f32_bf16 v53, v104, v32, 0
    v_dot2_f32_bf16 v54, v112, v32, 0
    v_dot2_f32_bf16 v55, v120, v32, 0
    v_dot2c_f32_bf16 v52, v97, v33
    v_dot2c_f32_bf16 v53, v105, v33
    v_dot2c_f32_bf16 v54, v113, v33
    v_dot2c_f32_bf16 v55, v121, v33
    v_dot2c_f32_bf16 v52, v98, v34
    v_dot2c_f32_bf16 v53, v106, v34
    v_dot2c_f32_bf16 v54, v114, v34
    v_dot2c_f32_bf16 v55, v122, v34
    v_dot2c_f32_bf16 v52, v99, v35
    v_dot2c_f32_bf16 v53, v107, v35
    v_dot2c_f32_bf16 v54, v115, v35
    v_dot2c_f32_bf16 v55, v123, v35
    v_dot2c_f32_bf16 v52, v100, v36
    v_dot2c_f32_bf16 v53, v108, v36
    v_dot2c_f32_bf16 v54, v116, v36
    v_dot2c_f32_bf16 v55, v124, v36
    v_dot2c_f32_bf16 v52, v101, v37
    v_dot2c_f32_bf16 v53, v109, v37
    v_dot2c_f32_bf16 v54, v117, v37
    v_dot2c_f32_bf16 v55, v125, v37
    v_dot2c_f32_bf16 v52, v102, v38
    v_dot2c_f32_bf16 v53, v110, v38
    v_dot2c_f32_bf16 v54, v118, v38
    v_dot2c_f32_bf16 v55, v126, v38
    v_dot2c_f32_bf16 v52, v103, v39
    v_dot2c_f32_bf16 v53, v111, v39
    v_dot2c_f32_bf16 v54, v119, v39
    v_dot2c_f32_bf16 v55, v127, v39
    s_nop 1
    v_add_f32_dpp v52, v52, v52 quad_perm:[1,0,3,2] row_mask:0xf bank_mask:0xf
    v_add_f32_dpp v53, v53, v53 quad_perm:[1,0,3,2] row_mask:0xf bank_mask:0xf
    v_add_f32_dpp v54, v54, v54 quad_perm:[1,0,3,2] row_mask:0xf bank_mask:0xf
    v_add_f32_dpp v55, v55, v55 quad_perm:[1,0,3,2] row_mask:0xf bank_mask:0xf
    s_nop 0
    v_add_f32_dpp v52, v52, v52 quad_perm:[2,3,0,1] row_mask:0xf bank_mask:0xf
    v_add_f32_dpp v53, v53, v53 quad_perm:[2,3,0,1] row_mask:0xf bank_mask:0xf
    v_add_f32_dpp v54, v54, v54 quad_perm:[2,3,0,1] row_mask:0xf bank_mask:0xf
    v_add_f32_dpp v55, v55, v55 quad_perm:[2,3,0,1] row_mask:0xf bank_mask:0xf
    v_mul_f32 v52, 0x3e38aa3b, v52
    v_mul_f32 v53, 0x3e38aa3b, v53
    v_mul_f32 v54, 0x3e38aa3b, v54
    v_mul_f32 v55, 0x3e38aa3b, v55
    v_exp_f32 v52, v52
    v_exp_f32 v53, v53
    v_exp_f32 v54, v54
    v_exp_f32 v55, v55
    s_nop 0
    v_add_f32 v8, v52, v53
    v_add_f32 v9, v54, v55
    v_add_f32 v59, v8, v9
    v_add_f32 v59, 0x3089705f, v59
    v_rcp_f32 v59, v59
    s_nop 0
    v_mul_f32 v52, v52, v59
    v_mul_f32 v53, v53, v59
    v_mul_f32 v54, v54, v59
    v_mul_f32 v55, v55, v59
    v_cvt_pk_bf16_f32 v8, v15, v52
    v_cvt_pk_bf16_f32 v52, v52, v15
    v_cvt_pk_bf16_f32 v9, v15, v53
    v_cvt_pk_bf16_f32 v53, v53, v15
    v_cvt_pk_bf16_f32 v10, v15, v54
    v_cvt_pk_bf16_f32 v54, v54, v15
    v_cvt_pk_bf16_f32 v11, v15, v55
    v_cvt_pk_bf16_f32 v55, v55, v15
    v_dot2_f32_bf16 v40, v96, v52, 0
    v_dot2_f32_bf16 v41, v96, v8, 0
    v_dot2_f32_bf16 v42, v97, v52, 0
    v_dot2_f32_bf16 v43, v97, v8, 0
    v_dot2_f32_bf16 v44, v98, v52, 0
    v_dot2_f32_bf16 v45, v98, v8, 0
    v_dot2_f32_bf16 v46, v99, v52, 0
    v_dot2_f32_bf16 v47, v99, v8, 0
    v_dot2c_f32_bf16 v40, v104, v53
    v_dot2c_f32_bf16 v41, v104, v9
    v_dot2c_f32_bf16 v42, v105, v53
    v_dot2c_f32_bf16 v43, v105, v9
    v_dot2c_f32_bf16 v44, v106, v53
    v_dot2c_f32_bf16 v45, v106, v9
    v_dot2c_f32_bf16 v46, v107, v53
    v_dot2c_f32_bf16 v47, v107, v9
    v_dot2c_f32_bf16 v40, v112, v54
    v_dot2c_f32_bf16 v41, v112, v10
    v_dot2c_f32_bf16 v42, v113, v54
    v_dot2c_f32_bf16 v43, v113, v10
    v_dot2c_f32_bf16 v44, v114, v54
    v_dot2c_f32_bf16 v45, v114, v10
    v_dot2c_f32_bf16 v46, v115, v54
    v_dot2c_f32_bf16 v47, v115, v10
    v_dot2c_f32_bf16 v40, v120, v55
    v_dot2c_f32_bf16 v41, v120, v11
    v_dot2c_f32_bf16 v42, v121, v55
    v_dot2c_f32_bf16 v43, v121, v11
    v_dot2c_f32_bf16 v44, v122, v55
    v_dot2c_f32_bf16 v45, v122, v11
    v_dot2c_f32_bf16 v46, v123, v55
    v_dot2c_f32_bf16 v47, v123, v11
    v_cvt_pk_bf16_f32 v96, v40, v41
    v_cvt_pk_bf16_f32 v97, v42, v43
    v_cvt_pk_bf16_f32 v98, v44, v45
    v_cvt_pk_bf16_f32 v99, v46, v47
    v_dot2_f32_bf16 v40, v100, v52, 0
    v_dot2_f32_bf16 v41, v100, v8, 0
    v_dot2_f32_bf16 v42, v101, v52, 0
    v_dot2_f32_bf16 v43, v101, v8, 0
    v_dot2_f32_bf16 v44, v102, v52, 0
    v_dot2_f32_bf16 v45, v102, v8, 0
    v_dot2_f32_bf16 v46, v103, v52, 0
    v_dot2_f32_bf16 v47, v103, v8, 0
    v_dot2c_f32_bf16 v40, v108, v53
    v_dot2c_f32_bf16 v41, v108, v9
    v_dot2c_f32_bf16 v42, v109, v53
    v_dot2c_f32_bf16 v43, v109, v9
    v_dot2c_f32_bf16 v44, v110, v53
    v_dot2c_f32_bf16 v45, v110, v9
    v_dot2c_f32_bf16 v46, v111, v53
    v_dot2c_f32_bf16 v47, v111, v9
    v_dot2c_f32_bf16 v40, v116, v54
    v_dot2c_f32_bf16 v41, v116, v10
    v_dot2c_f32_bf16 v42, v117, v54
    v_dot2c_f32_bf16 v43, v117, v10
    v_dot2c_f32_bf16 v44, v118, v54
    v_dot2c_f32_bf16 v45, v118, v10
    v_dot2c_f32_bf16 v46, v119, v54
    v_dot2c_f32_bf16 v47, v119, v10
    v_dot2c_f32_bf16 v40, v124, v55
    v_dot2c_f32_bf16 v41, v124, v11
    v_dot2c_f32_bf16 v42, v125, v55
    v_dot2c_f32_bf16 v43, v125, v11
    v_dot2c_f32_bf16 v44, v126, v55
    v_dot2c_f32_bf16 v45, v126, v11
    v_dot2c_f32_bf16 v46, v127, v55
    v_dot2c_f32_bf16 v47, v127, v11
    v_cvt_pk_bf16_f32 v100, v40, v41
    v_cvt_pk_bf16_f32 v101, v42, v43
    v_cvt_pk_bf16_f32 v102, v44, v45
    v_cvt_pk_bf16_f32 v103, v46, v47
    v_xor_b32 v9, 64, v6
    ds_write_b128 v6, v[96:99] offset:15872
    ds_write_b128 v9, v[100:103] offset:15872
    s_waitcnt lgkmcnt(0)
    v_cmpx_eq_u32 vcc, 0, v1
    ds_add_u32 v15, v12 offset:62488
    s_mov_b64 exec, -1
    v_mov_b32 v32, 0
    v_mov_b32 v33, 0
    v_mov_b32 v34, 0
    v_mov_b32 v35, 0
    v_mov_b32 v36, 0
    v_mov_b32 v37, 0
    v_mov_b32 v38, 0
    v_mov_b32 v39, 0
    v_mov_b32 v40, 0
    v_mov_b32 v41, 0
    v_mov_b32 v42, 0
    v_mov_b32 v43, 0
    v_mov_b32 v44, 0
    v_mov_b32 v45, 0
    v_mov_b32 v46, 0
    v_mov_b32 v47, 0
    s_cmp_eq_u32 s3, 0
    s_cselect_b32 s30, 4, 0
    v_and_b32 v8, s30, v1
    v_cmp_eq_u32 vcc, 0, v8
    v_mov_b32 v8, 196
    s_nop 0
    v_cndmask_b32 v63, v8, v13, vcc
    s_mul_i32 s30, s2, 196
    v_add_u32 v62, s30, v63
    v_min_u32 v8, 50000, v62
    v_lshlrev_b32 v8, 1, v8
    ds_read_u16 v60, v8 offset:63488
    ds_bpermute_b32 v61, v3, v63
    v_lshl_add_u32 v62, v62, 7, v2
    v_cmp_gt_u32 vcc, 196, v63
    v_mov_b32 v8, 0x7fffff00
    v_lshrrev_b32 v11, 4, v1
    v_cndmask_b32 v62, v8, v62, vcc
    s_waitcnt lgkmcnt(0)
    v_lshlrev_b32 v60, 16, v60
    v_and_b32 v8, 7, v61
    v_xor_b32 v8, v8, v11
    v_lshlrev_b32 v8, 4, v8
    v_lshl_add_u32 v61, v61, 7, v8
K_NOATT:
    v_cmp_lt_u32 vcc, s53, v56
    s_add_u32 s53, s53, 1
    s_nop 0
    v_cndmask_b32 v28, v57, v28, vcc
    v_lshl_add_u32 v10, v28, 7, v2
    buffer_load_dwordx4 v[96:99], v10, s[32:35], 0 offen
    buffer_load_dwordx4 v[100:103], v10, s[32:35], 0 offen offset:64
    v_lshlrev_b32 v9, 1, v28
    ds_read_u16 v52, v9 offset:63488
    ds_read_u16 v28, v7 offset:24
    v_cmp_lt_u32 vcc, s53, v56
    s_add_u32 s53, s53, 1
    s_nop 0
    v_cndmask_b32 v29, v57, v29, vcc
    v_lshl_add_u32 v10, v29, 7, v2
    buffer_load_dwordx4 v[104:107], v10, s[32:35], 0 offen
    buffer_load_dwordx4 v[108:111], v10, s[32:35], 0 offen offset:64
    v_lshlrev_b32 v9, 1, v29
    ds_read_u16 v53, v9 offset:63488
    ds_read_u16 v29, v7 offset:26
    v_cmp_lt_u32 vcc, s53, v56
    s_add_u32 s53, s53, 1
    s_nop 0
    v_cndmask_b32 v30, v57, v30, vcc
    v_lshl_add_u32 v10, v30, 7, v2
    buffer_load_dwordx4 v[112:115], v10, s[32:35], 0 offen
    buffer_load_dwordx4 v[116:119], v10, s[32:35], 0 offen offset:64
    v_lshlrev_b32 v9, 1, v30
    ds_read_u16 v54, v9 offset:63488
    ds_read_u16 v30, v7 offset:28
    v_cmp_lt_u32 vcc, s53, v56
    s_add_u32 s53, s53, 1
    s_nop 0
    v_cndmask_b32 v31, v57, v31, vcc
    v_lshl_add_u32 v10, v31, 7, v2
    buffer_load_dwordx4 v[120:123], v10, s[32:35], 0 offen
    buffer_load_dwordx4 v[124:127], v10, s[32:35], 0 offen offset:64
    v_lshlrev_b32 v9, 1, v31
    ds_read_u16 v55, v9 offset:63488
    ds_read_u16 v31, v7 offset:30
    s_max_u32 s52, s52, 8
    v_add_u32 v7, 16, v7
    s_setprio 0
    s_cmp_lt_u32 s3, 6
    s_cbranch_scc1 K_PMX
    s_setprio 1
    s_cmp_lt_u32 s3, 11
    s_cbranch_scc1 K_PMX
    s_setprio 0
K_PMX:
    s_cmp_ge_u32 s53, s52
    s_cbranch_scc1 K_DR0
K_LOOP:
    v_cmp_lt_u32 vcc, s53, v56
    s_waitcnt vmcnt(14) lgkmcnt(14)
    v_lshlrev_b32 v8, 16, v48
    v_dot2c_f32_bf16 v32, v64, v48
    v_dot2c_f32_bf16 v34, v65, v48
    v_dot2c_f32_bf16 v36, v66, v48
    v_dot2c_f32_bf16 v38, v67, v48
    v_dot2c_f32_bf16 v40, v68, v48
    v_dot2c_f32_bf16 v42, v69, v48
    v_dot2c_f32_bf16 v44, v70, v48
    v_dot2c_f32_bf16 v46, v71, v48
    v_dot2c_f32_bf16 v33, v64, v8
    v_dot2c_f32_bf16 v35, v65, v8
    v_dot2c_f32_bf16 v37, v66, v8
    v_dot2c_f32_bf16 v39, v67, v8
    v_dot2c_f32_bf16 v41, v68, v8
    v_dot2c_f32_bf16 v43, v69, v8
    v_dot2c_f32_bf16 v45, v70, v8
    v_dot2c_f32_bf16 v47, v71, v8
    v_cndmask_b32 v24, v57, v24, vcc
    v_lshl_add_u32 v10, v24, 7, v2
    buffer_load_dwordx4 v[64:67], v10, s[32:35], 0 offen
    buffer_load_dwordx4 v[68:71], v10, s[32:35], 0 offen offset:64
    v_lshlrev_b32 v9, 1, v24
    ds_read_u16 v48, v9 offset:63488
    ds_read_u16 v24, v7 offset:16
    s_add_u32 s53, s53, 1
    s_cmp_ge_u32 s53, s52
    s_cbranch_scc1 K_DR1
    v_cmp_lt_u32 vcc, s53, v56
    s_waitcnt vmcnt(14) lgkmcnt(14)
    v_lshlrev_b32 v8, 16, v49
    v_dot2c_f32_bf16 v32, v72, v49
    v_dot2c_f32_bf16 v34, v73, v49
    v_dot2c_f32_bf16 v36, v74, v49
    v_dot2c_f32_bf16 v38, v75, v49
    v_dot2c_f32_bf16 v40, v76, v49
    v_dot2c_f32_bf16 v42, v77, v49
    v_dot2c_f32_bf16 v44, v78, v49
    v_dot2c_f32_bf16 v46, v79, v49
    v_dot2c_f32_bf16 v33, v72, v8
    v_dot2c_f32_bf16 v35, v73, v8
    v_dot2c_f32_bf16 v37, v74, v8
    v_dot2c_f32_bf16 v39, v75, v8
    v_dot2c_f32_bf16 v41, v76, v8
    v_dot2c_f32_bf16 v43, v77, v8
    v_dot2c_f32_bf16 v45, v78, v8
    v_dot2c_f32_bf16 v47, v79, v8
    v_cndmask_b32 v25, v57, v25, vcc
    v_lshl_add_u32 v10, v25, 7, v2
    buffer_load_dwordx4 v[72:75], v10, s[32:35], 0 offen
    buffer_load_dwordx4 v[76:79], v10, s[32:35], 0 offen offset:64
    v_lshlrev_b32 v9, 1, v25
    ds_read_u16 v49, v9 offset:63488
    ds_read_u16 v25, v7 offset:18
    s_add_u32 s53, s53, 1
    s_cmp_ge_u32 s53, s52
    s_cbranch_scc1 K_DR2
    v_cmp_lt_u32 vcc, s53, v56
    s_waitcnt vmcnt(14) lgkmcnt(14)
    v_lshlrev_b32 v8, 16, v50
    v_dot2c_f32_bf16 v32, v80, v50
    v_dot2c_f32_bf16 v34, v81, v50
    v_dot2c_f32_bf16 v36, v82, v50
    v_dot2c_f32_bf16 v38, v83, v50
    v_dot2c_f32_bf16 v40, v84, v50
    v_dot2c_f32_bf16 v42, v85, v50
    v_dot2c_f32_bf16 v44, v86, v50
    v_dot2c_f32_bf16 v46, v87, v50
    v_dot2c_f32_bf16 v33, v80, v8
    v_dot2c_f32_bf16 v35, v81, v8
    v_dot2c_f32_bf16 v37, v82, v8
    v_dot2c_f32_bf16 v39, v83, v8
    v_dot2c_f32_bf16 v41, v84, v8
    v_dot2c_f32_bf16 v43, v85, v8
    v_dot2c_f32_bf16 v45, v86, v8
    v_dot2c_f32_bf16 v47, v87, v8
    v_cndmask_b32 v26, v57, v26, vcc
    v_lshl_add_u32 v10, v26, 7, v2
    buffer_load_dwordx4 v[80:83], v10, s[32:35], 0 offen
    buffer_load_dwordx4 v[84:87], v10, s[32:35], 0 offen offset:64
    v_lshlrev_b32 v9, 1, v26
    ds_read_u16 v50, v9 offset:63488
    ds_read_u16 v26, v7 offset:20
    s_add_u32 s53, s53, 1
    s_cmp_ge_u32 s53, s52
    s_cbranch_scc1 K_DR3
    v_cmp_lt_u32 vcc, s53, v56
    s_waitcnt vmcnt(14) lgkmcnt(14)
    v_lshlrev_b32 v8, 16, v51
    v_dot2c_f32_bf16 v32, v88, v51
    v_dot2c_f32_bf16 v34, v89, v51
    v_dot2c_f32_bf16 v36, v90, v51
    v_dot2c_f32_bf16 v38, v91, v51
    v_dot2c_f32_bf16 v40, v92, v51
    v_dot2c_f32_bf16 v42, v93, v51
    v_dot2c_f32_bf16 v44, v94, v51
    v_dot2c_f32_bf16 v46, v95, v51
    v_dot2c_f32_bf16 v33, v88, v8
    v_dot2c_f32_bf16 v35, v89, v8
    v_dot2c_f32_bf16 v37, v90, v8
    v_dot2c_f32_bf16 v39, v91, v8
    v_dot2c_f32_bf16 v41, v92, v8
    v_dot2c_f32_bf16 v43, v93, v8
    v_dot2c_f32_bf16 v45, v94, v8
    v_dot2c_f32_bf16 v47, v95, v8
    v_cndmask_b32 v27, v57, v27, vcc
    v_lshl_add_u32 v10, v27, 7, v2
    buffer_load_dwordx4 v[88:91], v10, s[32:35], 0 offen
    buffer_load_dwordx4 v[92:95], v10, s[32:35], 0 offen offset:64
    v_lshlrev_b32 v9, 1, v27
    ds_read_u16 v51, v9 offset:63488
    ds_read_u16 v27, v7 offset:22
    s_add_u32 s53, s53, 1
    s_cmp_ge_u32 s53, s52
    s_cbranch_scc1 K_DR4
    v_cmp_lt_u32 vcc, s53, v56
    s_waitcnt vmcnt(14) lgkmcnt(14)
    v_lshlrev_b32 v8, 16, v52
    v_dot2c_f32_bf16 v32, v96, v52
    v_dot2c_f32_bf16 v34, v97, v52
    v_dot2c_f32_bf16 v36, v98, v52
    v_dot2c_f32_bf16 v38, v99, v52
    v_dot2c_f32_bf16 v40, v100, v52
    v_dot2c_f32_bf16 v42, v101, v52
    v_dot2c_f32_bf16 v44, v102, v52
    v_dot2c_f32_bf16 v46, v103, v52
    v_dot2c_f32_bf16 v33, v96, v8
    v_dot2c_f32_bf16 v35, v97, v8
    v_dot2c_f32_bf16 v37, v98, v8
    v_dot2c_f32_bf16 v39, v99, v8
    v_dot2c_f32_bf16 v41, v100, v8
    v_dot2c_f32_bf16 v43, v101, v8
    v_dot2c_f32_bf16 v45, v102, v8
    v_dot2c_f32_bf16 v47, v103, v8
    v_cndmask_b32 v28, v57, v28, vcc
    v_lshl_add_u32 v10, v28, 7, v2
    buffer_load_dwordx4 v[96:99], v10, s[32:35], 0 offen
    buffer_load_dwordx4 v[100:103], v10, s[32:35], 0 offen offset:64
    v_lshlrev_b32 v9, 1, v28
    ds_read_u16 v52, v9 offset:63488
    ds_read_u16 v28, v7 offset:24
    s_add_u32 s53, s53, 1
    s_cmp_ge_u32 s53, s52
    s_cbranch_scc1 K_DR5
    v_cmp_lt_u32 vcc, s53, v56
    s_waitcnt vmcnt(14) lgkmcnt(14)
    v_lshlrev_b32 v8, 16, v53
    v_dot2c_f32_bf16 v32, v104, v53
    v_dot2c_f32_bf16 v34, v105, v53
    v_dot2c_f32_bf16 v36, v106, v53
    v_dot2c_f32_bf16 v38, v107, v53
    v_dot2c_f32_bf16 v40, v108, v53
    v_dot2c_f32_bf16 v42, v109, v53
    v_dot2c_f32_bf16 v44, v110, v53
    v_dot2c_f32_bf16 v46, v111, v53
    v_dot2c_f32_bf16 v33, v104, v8
    v_dot2c_f32_bf16 v35, v105, v8
    v_dot2c_f32_bf16 v37, v106, v8
    v_dot2c_f32_bf16 v39, v107, v8
    v_dot2c_f32_bf16 v41, v108, v8
    v_dot2c_f32_bf16 v43, v109, v8
    v_dot2c_f32_bf16 v45, v110, v8
    v_dot2c_f32_bf16 v47, v111, v8
    v_cndmask_b32 v29, v57, v29, vcc
    v_lshl_add_u32 v10, v29, 7, v2
    buffer_load_dwordx4 v[104:107], v10, s[32:35], 0 offen
    buffer_load_dwordx4 v[108:111], v10, s[32:35], 0 offen offset:64
    v_lshlrev_b32 v9, 1, v29
    ds_read_u16 v53, v9 offset:63488
    ds_read_u16 v29, v7 offset:26
    s_add_u32 s53, s53, 1
    s_cmp_ge_u32 s53, s52
    s_cbranch_scc1 K_DR6
    v_cmp_lt_u32 vcc, s53, v56
    s_waitcnt vmcnt(14) lgkmcnt(14)
    v_lshlrev_b32 v8, 16, v54
    v_dot2c_f32_bf16 v32, v112, v54
    v_dot2c_f32_bf16 v34, v113, v54
    v_dot2c_f32_bf16 v36, v114, v54
    v_dot2c_f32_bf16 v38, v115, v54
    v_dot2c_f32_bf16 v40, v116, v54
    v_dot2c_f32_bf16 v42, v117, v54
    v_dot2c_f32_bf16 v44, v118, v54
    v_dot2c_f32_bf16 v46, v119, v54
    v_dot2c_f32_bf16 v33, v112, v8
    v_dot2c_f32_bf16 v35, v113, v8
    v_dot2c_f32_bf16 v37, v114, v8
    v_dot2c_f32_bf16 v39, v115, v8
    v_dot2c_f32_bf16 v41, v116, v8
    v_dot2c_f32_bf16 v43, v117, v8
    v_dot2c_f32_bf16 v45, v118, v8
    v_dot2c_f32_bf16 v47, v119, v8
    v_cndmask_b32 v30, v57, v30, vcc
    v_lshl_add_u32 v10, v30, 7, v2
    buffer_load_dwordx4 v[112:115], v10, s[32:35], 0 offen
    buffer_load_dwordx4 v[116:119], v10, s[32:35], 0 offen offset:64
    v_lshlrev_b32 v9, 1, v30
    ds_read_u16 v54, v9 offset:63488
    ds_read_u16 v30, v7 offset:28
    s_add_u32 s53, s53, 1
    s_cmp_ge_u32 s53, s52
    s_cbranch_scc1 K_DR7
    v_cmp_lt_u32 vcc, s53, v56
    s_waitcnt vmcnt(14) lgkmcnt(14)
    v_lshlrev_b32 v8, 16, v55
    v_dot2c_f32_bf16 v32, v120, v55
    v_dot2c_f32_bf16 v34, v121, v55
    v_dot2c_f32_bf16 v36, v122, v55
    v_dot2c_f32_bf16 v38, v123, v55
    v_dot2c_f32_bf16 v40, v124, v55
    v_dot2c_f32_bf16 v42, v125, v55
    v_dot2c_f32_bf16 v44, v126, v55
    v_dot2c_f32_bf16 v46, v127, v55
    v_dot2c_f32_bf16 v33, v120, v8
    v_dot2c_f32_bf16 v35, v121, v8
    v_dot2c_f32_bf16 v37, v122, v8
    v_dot2c_f32_bf16 v39, v123, v8
    v_dot2c_f32_bf16 v41, v124, v8
    v_dot2c_f32_bf16 v43, v125, v8
    v_dot2c_f32_bf16 v45, v126, v8
    v_dot2c_f32_bf16 v47, v127, v8
    v_cndmask_b32 v31, v57, v31, vcc
    v_lshl_add_u32 v10, v31, 7, v2
    buffer_load_dwordx4 v[120:123], v10, s[32:35], 0 offen
    buffer_load_dwordx4 v[124:127], v10, s[32:35], 0 offen offset:64
    v_lshlrev_b32 v9, 1, v31
    ds_read_u16 v55, v9 offset:63488
    ds_read_u16 v31, v7 offset:30
    s_add_u32 s53, s53, 1
    v_add_u32 v7, 16, v7
    s_cmp_ge_u32 s53, s52
    s_cbranch_scc0 K_LOOP
K_DR0:
    s_waitcnt lgkmcnt(0)
    s_or_b32 s30, s55, s57
    s_cbranch_scc1 K_DRN0
    s_mov_b32 s62, 0
K_RW0:
    ds_read_b32 v11, v15 offset:62488
    s_add_u32 s62, s62, 1
    s_waitcnt lgkmcnt(0)
    v_readfirstlane_b32 s63, v11
    s_cmp_ge_u32 s62, 200000
    s_cbranch_scc1 K_RW0_X
    s_cmp_lt_u32 s63, 14
    s_cbranch_scc1 K_RW0
K_RW0_X:
    ds_read_b64_tr_b16 v[16:17], v5 offset:41216
    ds_read_b64_tr_b16 v[18:19], v5 offset:41792
    ds_read_b64_tr_b16 v[20:21], v5 offset:45824
    ds_read_b64_tr_b16 v[22:23], v5 offset:46400
    ds_read_b64_tr_b16 v[24:25], v5 offset:50432
    ds_read_b64_tr_b16 v[26:27], v5 offset:51008
    ds_read_b64_tr_b16 v[28:29], v5 offset:55040
    ds_read_b64_tr_b16 v[30:31], v5 offset:55616
K_DRN0:
    s_waitcnt vmcnt(14)
    v_lshlrev_b32 v8, 16, v48
    v_dot2c_f32_bf16 v32, v64, v48
    v_dot2c_f32_bf16 v34, v65, v48
    v_dot2c_f32_bf16 v36, v66, v48
    v_dot2c_f32_bf16 v38, v67, v48
    v_dot2c_f32_bf16 v40, v68, v48
    v_dot2c_f32_bf16 v42, v69, v48
    v_dot2c_f32_bf16 v44, v70, v48
    v_dot2c_f32_bf16 v46, v71, v48
    v_dot2c_f32_bf16 v33, v64, v8
    v_dot2c_f32_bf16 v35, v65, v8
    v_dot2c_f32_bf16 v37, v66, v8
    v_dot2c_f32_bf16 v39, v67, v8
    v_dot2c_f32_bf16 v41, v68, v8
    v_dot2c_f32_bf16 v43, v69, v8
    v_dot2c_f32_bf16 v45, v70, v8
    v_dot2c_f32_bf16 v47, v71, v8
    s_waitcnt vmcnt(12)
    v_lshlrev_b32 v8, 16, v49
    v_dot2c_f32_bf16 v32, v72, v49
    v_dot2c_f32_bf16 v34, v73, v49
    v_dot2c_f32_bf16 v36, v74, v49
    v_dot2c_f32_bf16 v38, v75, v49
    v_dot2c_f32_bf16 v40, v76, v49
    v_dot2c_f32_bf16 v42, v77, v49
    v_dot2c_f32_bf16 v44, v78, v49
    v_dot2c_f32_bf16 v46, v79, v49
    v_dot2c_f32_bf16 v33, v72, v8
    v_dot2c_f32_bf16 v35, v73, v8
    v_dot2c_f32_bf16 v37, v74, v8
    v_dot2c_f32_bf16 v39, v75, v8
    v_dot2c_f32_bf16 v41, v76, v8
    v_dot2c_f32_bf16 v43, v77, v8
    v_dot2c_f32_bf16 v45, v78, v8
    v_dot2c_f32_bf16 v47, v79, v8
    s_waitcnt vmcnt(10)
    v_lshlrev_b32 v8, 16, v50
    v_dot2c_f32_bf16 v32, v80, v50
    v_dot2c_f32_bf16 v34, v81, v50
    v_dot2c_f32_bf16 v36, v82, v50
    v_dot2c_f32_bf16 v38, v83, v50
    v_dot2c_f32_bf16 v40, v84, v50
    v_dot2c_f32_bf16 v42, v85, v50
    v_dot2c_f32_bf16 v44, v86, v50
    v_dot2c_f32_bf16 v46, v87, v50
    v_dot2c_f32_bf16 v33, v80, v8
    v_dot2c_f32_bf16 v35, v81, v8
    v_dot2c_f32_bf16 v37, v82, v8
    v_dot2c_f32_bf16 v39, v83, v8
    v_dot2c_f32_bf16 v41, v84, v8
    v_dot2c_f32_bf16 v43, v85, v8
    v_dot2c_f32_bf16 v45, v86, v8
    v_dot2c_f32_bf16 v47, v87, v8
    s_waitcnt vmcnt(8)
    v_lshlrev_b32 v8, 16, v51
    v_dot2c_f32_bf16 v32, v88, v51
    v_dot2c_f32_bf16 v34, v89, v51
    v_dot2c_f32_bf16 v36, v90, v51
    v_dot2c_f32_bf16 v38, v91, v51
    v_dot2c_f32_bf16 v40, v92, v51
    v_dot2c_f32_bf16 v42, v93, v51
    v_dot2c_f32_bf16 v44, v94, v51
    v_dot2c_f32_bf16 v46, v95, v51
    v_dot2c_f32_bf16 v33, v88, v8
    v_dot2c_f32_bf16 v35, v89, v8
    v_dot2c_f32_bf16 v37, v90, v8
    v_dot2c_f32_bf16 v39, v91, v8
    v_dot2c_f32_bf16 v41, v92, v8
    v_dot2c_f32_bf16 v43, v93, v8
    v_dot2c_f32_bf16 v45, v94, v8
    v_dot2c_f32_bf16 v47, v95, v8
    s_waitcnt vmcnt(6)
    v_lshlrev_b32 v8, 16, v52
    v_dot2c_f32_bf16 v32, v96, v52
    v_dot2c_f32_bf16 v34, v97, v52
    v_dot2c_f32_bf16 v36, v98, v52
    v_dot2c_f32_bf16 v38, v99, v52
    v_dot2c_f32_bf16 v40, v100, v52
    v_dot2c_f32_bf16 v42, v101, v52
    v_dot2c_f32_bf16 v44, v102, v52
    v_dot2c_f32_bf16 v46, v103, v52
    v_dot2c_f32_bf16 v33, v96, v8
    v_dot2c_f32_bf16 v35, v97, v8
    v_dot2c_f32_bf16 v37, v98, v8
    v_dot2c_f32_bf16 v39, v99, v8
    v_dot2c_f32_bf16 v41, v100, v8
    v_dot2c_f32_bf16 v43, v101, v8
    v_dot2c_f32_bf16 v45, v102, v8
    v_dot2c_f32_bf16 v47, v103, v8
    s_waitcnt vmcnt(4)
    v_lshlrev_b32 v8, 16, v53
    v_dot2c_f32_bf16 v32, v104, v53
    v_dot2c_f32_bf16 v34, v105, v53
    v_dot2c_f32_bf16 v36, v106, v53
    v_dot2c_f32_bf16 v38, v107, v53
    v_dot2c_f32_bf16 v40, v108, v53
    v_dot2c_f32_bf16 v42, v109, v53
    v_dot2c_f32_bf16 v44, v110, v53
    v_dot2c_f32_bf16 v46, v111, v53
    v_dot2c_f32_bf16 v33, v104, v8
    v_dot2c_f32_bf16 v35, v105, v8
    v_dot2c_f32_bf16 v37, v106, v8
    v_dot2c_f32_bf16 v39, v107, v8
    v_dot2c_f32_bf16 v41, v108, v8
    v_dot2c_f32_bf16 v43, v109, v8
    v_dot2c_f32_bf16 v45, v110, v8
    v_dot2c_f32_bf16 v47, v111, v8
    s_waitcnt vmcnt(2)
    v_lshlrev_b32 v8, 16, v54
    v_dot2c_f32_bf16 v32, v112, v54
    v_dot2c_f32_bf16 v34, v113, v54
    v_dot2c_f32_bf16 v36, v114, v54
    v_dot2c_f32_bf16 v38, v115, v54
    v_dot2c_f32_bf16 v40, v116, v54
    v_dot2c_f32_bf16 v42, v117, v54
    v_dot2c_f32_bf16 v44, v118, v54
    v_dot2c_f32_bf16 v46, v119, v54
    v_dot2c_f32_bf16 v33, v112, v8
    v_dot2c_f32_bf16 v35, v113, v8
    v_dot2c_f32_bf16 v37, v114, v8
    v_dot2c_f32_bf16 v39, v115, v8
    v_dot2c_f32_bf16 v41, v116, v8
    v_dot2c_f32_bf16 v43, v117, v8
    v_dot2c_f32_bf16 v45, v118, v8
    v_dot2c_f32_bf16 v47, v119, v8
    s_waitcnt vmcnt(0)
    v_lshlrev_b32 v8, 16, v55
    v_dot2c_f32_bf16 v32, v120, v55
    v_dot2c_f32_bf16 v34, v121, v55
    v_dot2c_f32_bf16 v36, v122, v55
    v_dot2c_f32_bf16 v38, v123, v55
    v_dot2c_f32_bf16 v40, v124, v55
    v_dot2c_f32_bf16 v42, v125, v55
    v_dot2c_f32_bf16 v44, v126, v55
    v_dot2c_f32_bf16 v46, v127, v55
    v_dot2c_f32_bf16 v33, v120, v8
    v_dot2c_f32_bf16 v35, v121, v8
    v_dot2c_f32_bf16 v37, v122, v8
    v_dot2c_f32_bf16 v39, v123, v8
    v_dot2c_f32_bf16 v41, v124, v8
    v_dot2c_f32_bf16 v43, v125, v8
    v_dot2c_f32_bf16 v45, v126, v8
    v_dot2c_f32_bf16 v47, v127, v8
    s_branch K_GDONE
K_DR1:
    s_waitcnt lgkmcnt(0)
    s_or_b32 s30, s55, s57
    s_cbranch_scc1 K_DRN1
    s_mov_b32 s62, 0
K_RW1:
    ds_read_b32 v11, v15 offset:62488
    s_add_u32 s62, s62, 1
    s_waitcnt lgkmcnt(0)
    v_readfirstlane_b32 s63, v11
    s_cmp_ge_u32 s62, 200000
    s_cbranch_scc1 K_RW1_X
    s_cmp_lt_u32 s63, 14
    s_cbranch_scc1 K_RW1
K_RW1_X:
    ds_read_b64_tr_b16 v[16:17], v5 offset:41216
    ds_read_b64_tr_b16 v[18:19], v5 offset:41792
    ds_read_b64_tr_b16 v[20:21], v5 offset:45824
    ds_read_b64_tr_b16 v[22:23], v5 offset:46400
    ds_read_b64_tr_b16 v[24:25], v5 offset:50432
    ds_read_b64_tr_b16 v[26:27], v5 offset:51008
    ds_read_b64_tr_b16 v[28:29], v5 offset:55040
    ds_read_b64_tr_b16 v[30:31], v5 offset:55616
K_DRN1:
    s_waitcnt vmcnt(14)
    v_lshlrev_b32 v8, 16, v49
    v_dot2c_f32_bf16 v32, v72, v49
    v_dot2c_f32_bf16 v34, v73, v49
    v_dot2c_f32_bf16 v36, v74, v49
    v_dot2c_f32_bf16 v38, v75, v49
    v_dot2c_f32_bf16 v40, v76, v49
    v_dot2c_f32_bf16 v42, v77, v49
    v_dot2c_f32_bf16 v44, v78, v49
    v_dot2c_f32_bf16 v46, v79, v49
    v_dot2c_f32_bf16 v33, v72, v8
    v_dot2c_f32_bf16 v35, v73, v8
    v_dot2c_f32_bf16 v37, v74, v8
    v_dot2c_f32_bf16 v39, v75, v8
    v_dot2c_f32_bf16 v41, v76, v8
    v_dot2c_f32_bf16 v43, v77, v8
    v_dot2c_f32_bf16 v45, v78, v8
    v_dot2c_f32_bf16 v47, v79, v8
    s_waitcnt vmcnt(12)
    v_lshlrev_b32 v8, 16, v50
    v_dot2c_f32_bf16 v32, v80, v50
    v_dot2c_f32_bf16 v34, v81, v50
    v_dot2c_f32_bf16 v36, v82, v50
    v_dot2c_f32_bf16 v38, v83, v50
    v_dot2c_f32_bf16 v40, v84, v50
    v_dot2c_f32_bf16 v42, v85, v50
    v_dot2c_f32_bf16 v44, v86, v50
    v_dot2c_f32_bf16 v46, v87, v50
    v_dot2c_f32_bf16 v33, v80, v8
    v_dot2c_f32_bf16 v35, v81, v8
    v_dot2c_f32_bf16 v37, v82, v8
    v_dot2c_f32_bf16 v39, v83, v8
    v_dot2c_f32_bf16 v41, v84, v8
    v_dot2c_f32_bf16 v43, v85, v8
    v_dot2c_f32_bf16 v45, v86, v8
    v_dot2c_f32_bf16 v47, v87, v8
    s_waitcnt vmcnt(10)
    v_lshlrev_b32 v8, 16, v51
    v_dot2c_f32_bf16 v32, v88, v51
    v_dot2c_f32_bf16 v34, v89, v51
    v_dot2c_f32_bf16 v36, v90, v51
    v_dot2c_f32_bf16 v38, v91, v51
    v_dot2c_f32_bf16 v40, v92, v51
    v_dot2c_f32_bf16 v42, v93, v51
    v_dot2c_f32_bf16 v44, v94, v51
    v_dot2c_f32_bf16 v46, v95, v51
    v_dot2c_f32_bf16 v33, v88, v8
    v_dot2c_f32_bf16 v35, v89, v8
    v_dot2c_f32_bf16 v37, v90, v8
    v_dot2c_f32_bf16 v39, v91, v8
    v_dot2c_f32_bf16 v41, v92, v8
    v_dot2c_f32_bf16 v43, v93, v8
    v_dot2c_f32_bf16 v45, v94, v8
    v_dot2c_f32_bf16 v47, v95, v8
    s_waitcnt vmcnt(8)
    v_lshlrev_b32 v8, 16, v52
    v_dot2c_f32_bf16 v32, v96, v52
    v_dot2c_f32_bf16 v34, v97, v52
    v_dot2c_f32_bf16 v36, v98, v52
    v_dot2c_f32_bf16 v38, v99, v52
    v_dot2c_f32_bf16 v40, v100, v52
    v_dot2c_f32_bf16 v42, v101, v52
    v_dot2c_f32_bf16 v44, v102, v52
    v_dot2c_f32_bf16 v46, v103, v52
    v_dot2c_f32_bf16 v33, v96, v8
    v_dot2c_f32_bf16 v35, v97, v8
    v_dot2c_f32_bf16 v37, v98, v8
    v_dot2c_f32_bf16 v39, v99, v8
    v_dot2c_f32_bf16 v41, v100, v8
    v_dot2c_f32_bf16 v43, v101, v8
    v_dot2c_f32_bf16 v45, v102, v8
    v_dot2c_f32_bf16 v47, v103, v8
    s_waitcnt vmcnt(6)
    v_lshlrev_b32 v8, 16, v53
    v_dot2c_f32_bf16 v32, v104, v53
    v_dot2c_f32_bf16 v34, v105, v53
    v_dot2c_f32_bf16 v36, v106, v53
    v_dot2c_f32_bf16 v38, v107, v53
    v_dot2c_f32_bf16 v40, v108, v53
    v_dot2c_f32_bf16 v42, v109, v53
    v_dot2c_f32_bf16 v44, v110, v53
    v_dot2c_f32_bf16 v46, v111, v53
    v_dot2c_f32_bf16 v33, v104, v8
    v_dot2c_f32_bf16 v35, v105, v8
    v_dot2c_f32_bf16 v37, v106, v8
    v_dot2c_f32_bf16 v39, v107, v8
    v_dot2c_f32_bf16 v41, v108, v8
    v_dot2c_f32_bf16 v43, v109, v8
    v_dot2c_f32_bf16 v45, v110, v8
    v_dot2c_f32_bf16 v47, v111, v8
    s_waitcnt vmcnt(4)
    v_lshlrev_b32 v8, 16, v54
    v_dot2c_f32_bf16 v32, v112, v54
    v_dot2c_f32_bf16 v34, v113, v54
    v_dot2c_f32_bf16 v36, v114, v54
    v_dot2c_f32_bf16 v38, v115, v54
    v_dot2c_f32_bf16 v40, v116, v54
    v_dot2c_f32_bf16 v42, v117, v54
    v_dot2c_f32_bf16 v44, v118, v54
    v_dot2c_f32_bf16 v46, v119, v54
    v_dot2c_f32_bf16 v33, v112, v8
    v_dot2c_f32_bf16 v35, v113, v8
    v_dot2c_f32_bf16 v37, v114, v8
    v_dot2c_f32_bf16 v39, v115, v8
    v_dot2c_f32_bf16 v41, v116, v8
    v_dot2c_f32_bf16 v43, v117, v8
    v_dot2c_f32_bf16 v45, v118, v8
    v_dot2c_f32_bf16 v47, v119, v8
    s_waitcnt vmcnt(2)
    v_lshlrev_b32 v8, 16, v55
    v_dot2c_f32_bf16 v32, v120, v55
    v_dot2c_f32_bf16 v34, v121, v55
    v_dot2c_f32_bf16 v36, v122, v55
    v_dot2c_f32_bf16 v38, v123, v55
    v_dot2c_f32_bf16 v40, v124, v55
    v_dot2c_f32_bf16 v42, v125, v55
    v_dot2c_f32_bf16 v44, v126, v55
    v_dot2c_f32_bf16 v46, v127, v55
    v_dot2c_f32_bf16 v33, v120, v8
    v_dot2c_f32_bf16 v35, v121, v8
    v_dot2c_f32_bf16 v37, v122, v8
    v_dot2c_f32_bf16 v39, v123, v8
    v_dot2c_f32_bf16 v41, v124, v8
    v_dot2c_f32_bf16 v43, v125, v8
    v_dot2c_f32_bf16 v45, v126, v8
    v_dot2c_f32_bf16 v47, v127, v8
    s_waitcnt vmcnt(0)
    v_lshlrev_b32 v8, 16, v48
    v_dot2c_f32_bf16 v32, v64, v48
    v_dot2c_f32_bf16 v34, v65, v48
    v_dot2c_f32_bf16 v36, v66, v48
    v_dot2c_f32_bf16 v38, v67, v48
    v_dot2c_f32_bf16 v40, v68, v48
    v_dot2c_f32_bf16 v42, v69, v48
    v_dot2c_f32_bf16 v44, v70, v48
    v_dot2c_f32_bf16 v46, v71, v48
    v_dot2c_f32_bf16 v33, v64, v8
    v_dot2c_f32_bf16 v35, v65, v8
    v_dot2c_f32_bf16 v37, v66, v8
    v_dot2c_f32_bf16 v39, v67, v8
    v_dot2c_f32_bf16 v41, v68, v8
    v_dot2c_f32_bf16 v43, v69, v8
    v_dot2c_f32_bf16 v45, v70, v8
    v_dot2c_f32_bf16 v47, v71, v8
    s_branch K_GDONE
K_DR2:
    s_waitcnt lgkmcnt(0)
    s_or_b32 s30, s55, s57
    s_cbranch_scc1 K_DRN2
    s_mov_b32 s62, 0
K_RW2:
    ds_read_b32 v11, v15 offset:62488
    s_add_u32 s62, s62, 1
    s_waitcnt lgkmcnt(0)
    v_readfirstlane_b32 s63, v11
    s_cmp_ge_u32 s62, 200000
    s_cbranch_scc1 K_RW2_X
    s_cmp_lt_u32 s63, 14
    s_cbranch_scc1 K_RW2
K_RW2_X:
    ds_read_b64_tr_b16 v[16:17], v5 offset:41216
    ds_read_b64_tr_b16 v[18:19], v5 offset:41792
    ds_read_b64_tr_b16 v[20:21], v5 offset:45824
    ds_read_b64_tr_b16 v[22:23], v5 offset:46400
    ds_read_b64_tr_b16 v[24:25], v5 offset:50432
    ds_read_b64_tr_b16 v[26:27], v5 offset:51008
    ds_read_b64_tr_b16 v[28:29], v5 offset:55040
    ds_read_b64_tr_b16 v[30:31], v5 offset:55616
K_DRN2:
    s_waitcnt vmcnt(14)
    v_lshlrev_b32 v8, 16, v50
    v_dot2c_f32_bf16 v32, v80, v50
    v_dot2c_f32_bf16 v34, v81, v50
    v_dot2c_f32_bf16 v36, v82, v50
    v_dot2c_f32_bf16 v38, v83, v50
    v_dot2c_f32_bf16 v40, v84, v50
    v_dot2c_f32_bf16 v42, v85, v50
    v_dot2c_f32_bf16 v44, v86, v50
    v_dot2c_f32_bf16 v46, v87, v50
    v_dot2c_f32_bf16 v33, v80, v8
    v_dot2c_f32_bf16 v35, v81, v8
    v_dot2c_f32_bf16 v37, v82, v8
    v_dot2c_f32_bf16 v39, v83, v8
    v_dot2c_f32_bf16 v41, v84, v8
    v_dot2c_f32_bf16 v43, v85, v8
    v_dot2c_f32_bf16 v45, v86, v8
    v_dot2c_f32_bf16 v47, v87, v8
    s_waitcnt vmcnt(12)
    v_lshlrev_b32 v8, 16, v51
    v_dot2c_f32_bf16 v32, v88, v51
    v_dot2c_f32_bf16 v34, v89, v51
    v_dot2c_f32_bf16 v36, v90, v51
    v_dot2c_f32_bf16 v38, v91, v51
    v_dot2c_f32_bf16 v40, v92, v51
    v_dot2c_f32_bf16 v42, v93, v51
    v_dot2c_f32_bf16 v44, v94, v51
    v_dot2c_f32_bf16 v46, v95, v51
    v_dot2c_f32_bf16 v33, v88, v8
    v_dot2c_f32_bf16 v35, v89, v8
    v_dot2c_f32_bf16 v37, v90, v8
    v_dot2c_f32_bf16 v39, v91, v8
    v_dot2c_f32_bf16 v41, v92, v8
    v_dot2c_f32_bf16 v43, v93, v8
    v_dot2c_f32_bf16 v45, v94, v8
    v_dot2c_f32_bf16 v47, v95, v8
    s_waitcnt vmcnt(10)
    v_lshlrev_b32 v8, 16, v52
    v_dot2c_f32_bf16 v32, v96, v52
    v_dot2c_f32_bf16 v34, v97, v52
    v_dot2c_f32_bf16 v36, v98, v52
    v_dot2c_f32_bf16 v38, v99, v52
    v_dot2c_f32_bf16 v40, v100, v52
    v_dot2c_f32_bf16 v42, v101, v52
    v_dot2c_f32_bf16 v44, v102, v52
    v_dot2c_f32_bf16 v46, v103, v52
    v_dot2c_f32_bf16 v33, v96, v8
    v_dot2c_f32_bf16 v35, v97, v8
    v_dot2c_f32_bf16 v37, v98, v8
    v_dot2c_f32_bf16 v39, v99, v8
    v_dot2c_f32_bf16 v41, v100, v8
    v_dot2c_f32_bf16 v43, v101, v8
    v_dot2c_f32_bf16 v45, v102, v8
    v_dot2c_f32_bf16 v47, v103, v8
    s_waitcnt vmcnt(8)
    v_lshlrev_b32 v8, 16, v53
    v_dot2c_f32_bf16 v32, v104, v53
    v_dot2c_f32_bf16 v34, v105, v53
    v_dot2c_f32_bf16 v36, v106, v53
    v_dot2c_f32_bf16 v38, v107, v53
    v_dot2c_f32_bf16 v40, v108, v53
    v_dot2c_f32_bf16 v42, v109, v53
    v_dot2c_f32_bf16 v44, v110, v53
    v_dot2c_f32_bf16 v46, v111, v53
    v_dot2c_f32_bf16 v33, v104, v8
    v_dot2c_f32_bf16 v35, v105, v8
    v_dot2c_f32_bf16 v37, v106, v8
    v_dot2c_f32_bf16 v39, v107, v8
    v_dot2c_f32_bf16 v41, v108, v8
    v_dot2c_f32_bf16 v43, v109, v8
    v_dot2c_f32_bf16 v45, v110, v8
    v_dot2c_f32_bf16 v47, v111, v8
    s_waitcnt vmcnt(6)
    v_lshlrev_b32 v8, 16, v54
    v_dot2c_f32_bf16 v32, v112, v54
    v_dot2c_f32_bf16 v34, v113, v54
    v_dot2c_f32_bf16 v36, v114, v54
    v_dot2c_f32_bf16 v38, v115, v54
    v_dot2c_f32_bf16 v40, v116, v54
    v_dot2c_f32_bf16 v42, v117, v54
    v_dot2c_f32_bf16 v44, v118, v54
    v_dot2c_f32_bf16 v46, v119, v54
    v_dot2c_f32_bf16 v33, v112, v8
    v_dot2c_f32_bf16 v35, v113, v8
    v_dot2c_f32_bf16 v37, v114, v8
    v_dot2c_f32_bf16 v39, v115, v8
    v_dot2c_f32_bf16 v41, v116, v8
    v_dot2c_f32_bf16 v43, v117, v8
    v_dot2c_f32_bf16 v45, v118, v8
    v_dot2c_f32_bf16 v47, v119, v8
    s_waitcnt vmcnt(4)
    v_lshlrev_b32 v8, 16, v55
    v_dot2c_f32_bf16 v32, v120, v55
    v_dot2c_f32_bf16 v34, v121, v55
    v_dot2c_f32_bf16 v36, v122, v55
    v_dot2c_f32_bf16 v38, v123, v55
    v_dot2c_f32_bf16 v40, v124, v55
    v_dot2c_f32_bf16 v42, v125, v55
    v_dot2c_f32_bf16 v44, v126, v55
    v_dot2c_f32_bf16 v46, v127, v55
    v_dot2c_f32_bf16 v33, v120, v8
    v_dot2c_f32_bf16 v35, v121, v8
    v_dot2c_f32_bf16 v37, v122, v8
    v_dot2c_f32_bf16 v39, v123, v8
    v_dot2c_f32_bf16 v41, v124, v8
    v_dot2c_f32_bf16 v43, v125, v8
    v_dot2c_f32_bf16 v45, v126, v8
    v_dot2c_f32_bf16 v47, v127, v8
    s_waitcnt vmcnt(2)
    v_lshlrev_b32 v8, 16, v48
    v_dot2c_f32_bf16 v32, v64, v48
    v_dot2c_f32_bf16 v34, v65, v48
    v_dot2c_f32_bf16 v36, v66, v48
    v_dot2c_f32_bf16 v38, v67, v48
    v_dot2c_f32_bf16 v40, v68, v48
    v_dot2c_f32_bf16 v42, v69, v48
    v_dot2c_f32_bf16 v44, v70, v48
    v_dot2c_f32_bf16 v46, v71, v48
    v_dot2c_f32_bf16 v33, v64, v8
    v_dot2c_f32_bf16 v35, v65, v8
    v_dot2c_f32_bf16 v37, v66, v8
    v_dot2c_f32_bf16 v39, v67, v8
    v_dot2c_f32_bf16 v41, v68, v8
    v_dot2c_f32_bf16 v43, v69, v8
    v_dot2c_f32_bf16 v45, v70, v8
    v_dot2c_f32_bf16 v47, v71, v8
    s_waitcnt vmcnt(0)
    v_lshlrev_b32 v8, 16, v49
    v_dot2c_f32_bf16 v32, v72, v49
    v_dot2c_f32_bf16 v34, v73, v49
    v_dot2c_f32_bf16 v36, v74, v49
    v_dot2c_f32_bf16 v38, v75, v49
    v_dot2c_f32_bf16 v40, v76, v49
    v_dot2c_f32_bf16 v42, v77, v49
    v_dot2c_f32_bf16 v44, v78, v49
    v_dot2c_f32_bf16 v46, v79, v49
    v_dot2c_f32_bf16 v33, v72, v8
    v_dot2c_f32_bf16 v35, v73, v8
    v_dot2c_f32_bf16 v37, v74, v8
    v_dot2c_f32_bf16 v39, v75, v8
    v_dot2c_f32_bf16 v41, v76, v8
    v_dot2c_f32_bf16 v43, v77, v8
    v_dot2c_f32_bf16 v45, v78, v8
    v_dot2c_f32_bf16 v47, v79, v8
    s_branch K_GDONE
K_DR3:
    s_waitcnt lgkmcnt(0)
    s_or_b32 s30, s55, s57
    s_cbranch_scc1 K_DRN3
    s_mov_b32 s62, 0
K_RW3:
    ds_read_b32 v11, v15 offset:62488
    s_add_u32 s62, s62, 1
    s_waitcnt lgkmcnt(0)
    v_readfirstlane_b32 s63, v11
    s_cmp_ge_u32 s62, 200000
    s_cbranch_scc1 K_RW3_X
    s_cmp_lt_u32 s63, 14
    s_cbranch_scc1 K_RW3
K_RW3_X:
    ds_read_b64_tr_b16 v[16:17], v5 offset:41216
    ds_read_b64_tr_b16 v[18:19], v5 offset:41792
    ds_read_b64_tr_b16 v[20:21], v5 offset:45824
    ds_read_b64_tr_b16 v[22:23], v5 offset:46400
    ds_read_b64_tr_b16 v[24:25], v5 offset:50432
    ds_read_b64_tr_b16 v[26:27], v5 offset:51008
    ds_read_b64_tr_b16 v[28:29], v5 offset:55040
    ds_read_b64_tr_b16 v[30:31], v5 offset:55616
K_DRN3:
    s_waitcnt vmcnt(14)
    v_lshlrev_b32 v8, 16, v51
    v_dot2c_f32_bf16 v32, v88, v51
    v_dot2c_f32_bf16 v34, v89, v51
    v_dot2c_f32_bf16 v36, v90, v51
    v_dot2c_f32_bf16 v38, v91, v51
    v_dot2c_f32_bf16 v40, v92, v51
    v_dot2c_f32_bf16 v42, v93, v51
    v_dot2c_f32_bf16 v44, v94, v51
    v_dot2c_f32_bf16 v46, v95, v51
    v_dot2c_f32_bf16 v33, v88, v8
    v_dot2c_f32_bf16 v35, v89, v8
    v_dot2c_f32_bf16 v37, v90, v8
    v_dot2c_f32_bf16 v39, v91, v8
    v_dot2c_f32_bf16 v41, v92, v8
    v_dot2c_f32_bf16 v43, v93, v8
    v_dot2c_f32_bf16 v45, v94, v8
    v_dot2c_f32_bf16 v47, v95, v8
    s_waitcnt vmcnt(12)
    v_lshlrev_b32 v8, 16, v52
    v_dot2c_f32_bf16 v32, v96, v52
    v_dot2c_f32_bf16 v34, v97, v52
    v_dot2c_f32_bf16 v36, v98, v52
    v_dot2c_f32_bf16 v38, v99, v52
    v_dot2c_f32_bf16 v40, v100, v52
    v_dot2c_f32_bf16 v42, v101, v52
    v_dot2c_f32_bf16 v44, v102, v52
    v_dot2c_f32_bf16 v46, v103, v52
    v_dot2c_f32_bf16 v33, v96, v8
    v_dot2c_f32_bf16 v35, v97, v8
    v_dot2c_f32_bf16 v37, v98, v8
    v_dot2c_f32_bf16 v39, v99, v8
    v_dot2c_f32_bf16 v41, v100, v8
    v_dot2c_f32_bf16 v43, v101, v8
    v_dot2c_f32_bf16 v45, v102, v8
    v_dot2c_f32_bf16 v47, v103, v8
    s_waitcnt vmcnt(10)
    v_lshlrev_b32 v8, 16, v53
    v_dot2c_f32_bf16 v32, v104, v53
    v_dot2c_f32_bf16 v34, v105, v53
    v_dot2c_f32_bf16 v36, v106, v53
    v_dot2c_f32_bf16 v38, v107, v53
    v_dot2c_f32_bf16 v40, v108, v53
    v_dot2c_f32_bf16 v42, v109, v53
    v_dot2c_f32_bf16 v44, v110, v53
    v_dot2c_f32_bf16 v46, v111, v53
    v_dot2c_f32_bf16 v33, v104, v8
    v_dot2c_f32_bf16 v35, v105, v8
    v_dot2c_f32_bf16 v37, v106, v8
    v_dot2c_f32_bf16 v39, v107, v8
    v_dot2c_f32_bf16 v41, v108, v8
    v_dot2c_f32_bf16 v43, v109, v8
    v_dot2c_f32_bf16 v45, v110, v8
    v_dot2c_f32_bf16 v47, v111, v8
    s_waitcnt vmcnt(8)
    v_lshlrev_b32 v8, 16, v54
    v_dot2c_f32_bf16 v32, v112, v54
    v_dot2c_f32_bf16 v34, v113, v54
    v_dot2c_f32_bf16 v36, v114, v54
    v_dot2c_f32_bf16 v38, v115, v54
    v_dot2c_f32_bf16 v40, v116, v54
    v_dot2c_f32_bf16 v42, v117, v54
    v_dot2c_f32_bf16 v44, v118, v54
    v_dot2c_f32_bf16 v46, v119, v54
    v_dot2c_f32_bf16 v33, v112, v8
    v_dot2c_f32_bf16 v35, v113, v8
    v_dot2c_f32_bf16 v37, v114, v8
    v_dot2c_f32_bf16 v39, v115, v8
    v_dot2c_f32_bf16 v41, v116, v8
    v_dot2c_f32_bf16 v43, v117, v8
    v_dot2c_f32_bf16 v45, v118, v8
    v_dot2c_f32_bf16 v47, v119, v8
    s_waitcnt vmcnt(6)
    v_lshlrev_b32 v8, 16, v55
    v_dot2c_f32_bf16 v32, v120, v55
    v_dot2c_f32_bf16 v34, v121, v55
    v_dot2c_f32_bf16 v36, v122, v55
    v_dot2c_f32_bf16 v38, v123, v55
    v_dot2c_f32_bf16 v40, v124, v55
    v_dot2c_f32_bf16 v42, v125, v55
    v_dot2c_f32_bf16 v44, v126, v55
    v_dot2c_f32_bf16 v46, v127, v55
    v_dot2c_f32_bf16 v33, v120, v8
    v_dot2c_f32_bf16 v35, v121, v8
    v_dot2c_f32_bf16 v37, v122, v8
    v_dot2c_f32_bf16 v39, v123, v8
    v_dot2c_f32_bf16 v41, v124, v8
    v_dot2c_f32_bf16 v43, v125, v8
    v_dot2c_f32_bf16 v45, v126, v8
    v_dot2c_f32_bf16 v47, v127, v8
    s_waitcnt vmcnt(4)
    v_lshlrev_b32 v8, 16, v48
    v_dot2c_f32_bf16 v32, v64, v48
    v_dot2c_f32_bf16 v34, v65, v48
    v_dot2c_f32_bf16 v36, v66, v48
    v_dot2c_f32_bf16 v38, v67, v48
    v_dot2c_f32_bf16 v40, v68, v48
    v_dot2c_f32_bf16 v42, v69, v48
    v_dot2c_f32_bf16 v44, v70, v48
    v_dot2c_f32_bf16 v46, v71, v48
    v_dot2c_f32_bf16 v33, v64, v8
    v_dot2c_f32_bf16 v35, v65, v8
    v_dot2c_f32_bf16 v37, v66, v8
    v_dot2c_f32_bf16 v39, v67, v8
    v_dot2c_f32_bf16 v41, v68, v8
    v_dot2c_f32_bf16 v43, v69, v8
    v_dot2c_f32_bf16 v45, v70, v8
    v_dot2c_f32_bf16 v47, v71, v8
    s_waitcnt vmcnt(2)
    v_lshlrev_b32 v8, 16, v49
    v_dot2c_f32_bf16 v32, v72, v49
    v_dot2c_f32_bf16 v34, v73, v49
    v_dot2c_f32_bf16 v36, v74, v49
    v_dot2c_f32_bf16 v38, v75, v49
    v_dot2c_f32_bf16 v40, v76, v49
    v_dot2c_f32_bf16 v42, v77, v49
    v_dot2c_f32_bf16 v44, v78, v49
    v_dot2c_f32_bf16 v46, v79, v49
    v_dot2c_f32_bf16 v33, v72, v8
    v_dot2c_f32_bf16 v35, v73, v8
    v_dot2c_f32_bf16 v37, v74, v8
    v_dot2c_f32_bf16 v39, v75, v8
    v_dot2c_f32_bf16 v41, v76, v8
    v_dot2c_f32_bf16 v43, v77, v8
    v_dot2c_f32_bf16 v45, v78, v8
    v_dot2c_f32_bf16 v47, v79, v8
    s_waitcnt vmcnt(0)
    v_lshlrev_b32 v8, 16, v50
    v_dot2c_f32_bf16 v32, v80, v50
    v_dot2c_f32_bf16 v34, v81, v50
    v_dot2c_f32_bf16 v36, v82, v50
    v_dot2c_f32_bf16 v38, v83, v50
    v_dot2c_f32_bf16 v40, v84, v50
    v_dot2c_f32_bf16 v42, v85, v50
    v_dot2c_f32_bf16 v44, v86, v50
    v_dot2c_f32_bf16 v46, v87, v50
    v_dot2c_f32_bf16 v33, v80, v8
    v_dot2c_f32_bf16 v35, v81, v8
    v_dot2c_f32_bf16 v37, v82, v8
    v_dot2c_f32_bf16 v39, v83, v8
    v_dot2c_f32_bf16 v41, v84, v8
    v_dot2c_f32_bf16 v43, v85, v8
    v_dot2c_f32_bf16 v45, v86, v8
    v_dot2c_f32_bf16 v47, v87, v8
    s_branch K_GDONE
K_DR4:
    s_waitcnt lgkmcnt(0)
    s_or_b32 s30, s55, s57
    s_cbranch_scc1 K_DRN4
    s_mov_b32 s62, 0
K_RW4:
    ds_read_b32 v11, v15 offset:62488
    s_add_u32 s62, s62, 1
    s_waitcnt lgkmcnt(0)
    v_readfirstlane_b32 s63, v11
    s_cmp_ge_u32 s62, 200000
    s_cbranch_scc1 K_RW4_X
    s_cmp_lt_u32 s63, 14
    s_cbranch_scc1 K_RW4
K_RW4_X:
    ds_read_b64_tr_b16 v[16:17], v5 offset:41216
    ds_read_b64_tr_b16 v[18:19], v5 offset:41792
    ds_read_b64_tr_b16 v[20:21], v5 offset:45824
    ds_read_b64_tr_b16 v[22:23], v5 offset:46400
    ds_read_b64_tr_b16 v[24:25], v5 offset:50432
    ds_read_b64_tr_b16 v[26:27], v5 offset:51008
    ds_read_b64_tr_b16 v[28:29], v5 offset:55040
    ds_read_b64_tr_b16 v[30:31], v5 offset:55616
K_DRN4:
    s_waitcnt vmcnt(14)
    v_lshlrev_b32 v8, 16, v52
    v_dot2c_f32_bf16 v32, v96, v52
    v_dot2c_f32_bf16 v34, v97, v52
    v_dot2c_f32_bf16 v36, v98, v52
    v_dot2c_f32_bf16 v38, v99, v52
    v_dot2c_f32_bf16 v40, v100, v52
    v_dot2c_f32_bf16 v42, v101, v52
    v_dot2c_f32_bf16 v44, v102, v52
    v_dot2c_f32_bf16 v46, v103, v52
    v_dot2c_f32_bf16 v33, v96, v8
    v_dot2c_f32_bf16 v35, v97, v8
    v_dot2c_f32_bf16 v37, v98, v8
    v_dot2c_f32_bf16 v39, v99, v8
    v_dot2c_f32_bf16 v41, v100, v8
    v_dot2c_f32_bf16 v43, v101, v8
    v_dot2c_f32_bf16 v45, v102, v8
    v_dot2c_f32_bf16 v47, v103, v8
    s_waitcnt vmcnt(12)
    v_lshlrev_b32 v8, 16, v53
    v_dot2c_f32_bf16 v32, v104, v53
    v_dot2c_f32_bf16 v34, v105, v53
    v_dot2c_f32_bf16 v36, v106, v53
    v_dot2c_f32_bf16 v38, v107, v53
    v_dot2c_f32_bf16 v40, v108, v53
    v_dot2c_f32_bf16 v42, v109, v53
    v_dot2c_f32_bf16 v44, v110, v53
    v_dot2c_f32_bf16 v46, v111, v53
    v_dot2c_f32_bf16 v33, v104, v8
    v_dot2c_f32_bf16 v35, v105, v8
    v_dot2c_f32_bf16 v37, v106, v8
    v_dot2c_f32_bf16 v39, v107, v8
    v_dot2c_f32_bf16 v41, v108, v8
    v_dot2c_f32_bf16 v43, v109, v8
    v_dot2c_f32_bf16 v45, v110, v8
    v_dot2c_f32_bf16 v47, v111, v8
    s_waitcnt vmcnt(10)
    v_lshlrev_b32 v8, 16, v54
    v_dot2c_f32_bf16 v32, v112, v54
    v_dot2c_f32_bf16 v34, v113, v54
    v_dot2c_f32_bf16 v36, v114, v54
    v_dot2c_f32_bf16 v38, v115, v54
    v_dot2c_f32_bf16 v40, v116, v54
    v_dot2c_f32_bf16 v42, v117, v54
    v_dot2c_f32_bf16 v44, v118, v54
    v_dot2c_f32_bf16 v46, v119, v54
    v_dot2c_f32_bf16 v33, v112, v8
    v_dot2c_f32_bf16 v35, v113, v8
    v_dot2c_f32_bf16 v37, v114, v8
    v_dot2c_f32_bf16 v39, v115, v8
    v_dot2c_f32_bf16 v41, v116, v8
    v_dot2c_f32_bf16 v43, v117, v8
    v_dot2c_f32_bf16 v45, v118, v8
    v_dot2c_f32_bf16 v47, v119, v8
    s_waitcnt vmcnt(8)
    v_lshlrev_b32 v8, 16, v55
    v_dot2c_f32_bf16 v32, v120, v55
    v_dot2c_f32_bf16 v34, v121, v55
    v_dot2c_f32_bf16 v36, v122, v55
    v_dot2c_f32_bf16 v38, v123, v55
    v_dot2c_f32_bf16 v40, v124, v55
    v_dot2c_f32_bf16 v42, v125, v55
    v_dot2c_f32_bf16 v44, v126, v55
    v_dot2c_f32_bf16 v46, v127, v55
    v_dot2c_f32_bf16 v33, v120, v8
    v_dot2c_f32_bf16 v35, v121, v8
    v_dot2c_f32_bf16 v37, v122, v8
    v_dot2c_f32_bf16 v39, v123, v8
    v_dot2c_f32_bf16 v41, v124, v8
    v_dot2c_f32_bf16 v43, v125, v8
    v_dot2c_f32_bf16 v45, v126, v8
    v_dot2c_f32_bf16 v47, v127, v8
    s_waitcnt vmcnt(6)
    v_lshlrev_b32 v8, 16, v48
    v_dot2c_f32_bf16 v32, v64, v48
    v_dot2c_f32_bf16 v34, v65, v48
    v_dot2c_f32_bf16 v36, v66, v48
    v_dot2c_f32_bf16 v38, v67, v48
    v_dot2c_f32_bf16 v40, v68, v48
    v_dot2c_f32_bf16 v42, v69, v48
    v_dot2c_f32_bf16 v44, v70, v48
    v_dot2c_f32_bf16 v46, v71, v48
    v_dot2c_f32_bf16 v33, v64, v8
    v_dot2c_f32_bf16 v35, v65, v8
    v_dot2c_f32_bf16 v37, v66, v8
    v_dot2c_f32_bf16 v39, v67, v8
    v_dot2c_f32_bf16 v41, v68, v8
    v_dot2c_f32_bf16 v43, v69, v8
    v_dot2c_f32_bf16 v45, v70, v8
    v_dot2c_f32_bf16 v47, v71, v8
    s_waitcnt vmcnt(4)
    v_lshlrev_b32 v8, 16, v49
    v_dot2c_f32_bf16 v32, v72, v49
    v_dot2c_f32_bf16 v34, v73, v49
    v_dot2c_f32_bf16 v36, v74, v49
    v_dot2c_f32_bf16 v38, v75, v49
    v_dot2c_f32_bf16 v40, v76, v49
    v_dot2c_f32_bf16 v42, v77, v49
    v_dot2c_f32_bf16 v44, v78, v49
    v_dot2c_f32_bf16 v46, v79, v49
    v_dot2c_f32_bf16 v33, v72, v8
    v_dot2c_f32_bf16 v35, v73, v8
    v_dot2c_f32_bf16 v37, v74, v8
    v_dot2c_f32_bf16 v39, v75, v8
    v_dot2c_f32_bf16 v41, v76, v8
    v_dot2c_f32_bf16 v43, v77, v8
    v_dot2c_f32_bf16 v45, v78, v8
    v_dot2c_f32_bf16 v47, v79, v8
    s_waitcnt vmcnt(2)
    v_lshlrev_b32 v8, 16, v50
    v_dot2c_f32_bf16 v32, v80, v50
    v_dot2c_f32_bf16 v34, v81, v50
    v_dot2c_f32_bf16 v36, v82, v50
    v_dot2c_f32_bf16 v38, v83, v50
    v_dot2c_f32_bf16 v40, v84, v50
    v_dot2c_f32_bf16 v42, v85, v50
    v_dot2c_f32_bf16 v44, v86, v50
    v_dot2c_f32_bf16 v46, v87, v50
    v_dot2c_f32_bf16 v33, v80, v8
    v_dot2c_f32_bf16 v35, v81, v8
    v_dot2c_f32_bf16 v37, v82, v8
    v_dot2c_f32_bf16 v39, v83, v8
    v_dot2c_f32_bf16 v41, v84, v8
    v_dot2c_f32_bf16 v43, v85, v8
    v_dot2c_f32_bf16 v45, v86, v8
    v_dot2c_f32_bf16 v47, v87, v8
    s_waitcnt vmcnt(0)
    v_lshlrev_b32 v8, 16, v51
    v_dot2c_f32_bf16 v32, v88, v51
    v_dot2c_f32_bf16 v34, v89, v51
    v_dot2c_f32_bf16 v36, v90, v51
    v_dot2c_f32_bf16 v38, v91, v51
    v_dot2c_f32_bf16 v40, v92, v51
    v_dot2c_f32_bf16 v42, v93, v51
    v_dot2c_f32_bf16 v44, v94, v51
    v_dot2c_f32_bf16 v46, v95, v51
    v_dot2c_f32_bf16 v33, v88, v8
    v_dot2c_f32_bf16 v35, v89, v8
    v_dot2c_f32_bf16 v37, v90, v8
    v_dot2c_f32_bf16 v39, v91, v8
    v_dot2c_f32_bf16 v41, v92, v8
    v_dot2c_f32_bf16 v43, v93, v8
    v_dot2c_f32_bf16 v45, v94, v8
    v_dot2c_f32_bf16 v47, v95, v8
    s_branch K_GDONE
K_DR5:
    s_waitcnt lgkmcnt(0)
    s_or_b32 s30, s55, s57
    s_cbranch_scc1 K_DRN5
    s_mov_b32 s62, 0
K_RW5:
    ds_read_b32 v11, v15 offset:62488
    s_add_u32 s62, s62, 1
    s_waitcnt lgkmcnt(0)
    v_readfirstlane_b32 s63, v11
    s_cmp_ge_u32 s62, 200000
    s_cbranch_scc1 K_RW5_X
    s_cmp_lt_u32 s63, 14
    s_cbranch_scc1 K_RW5
K_RW5_X:
    ds_read_b64_tr_b16 v[16:17], v5 offset:41216
    ds_read_b64_tr_b16 v[18:19], v5 offset:41792
    ds_read_b64_tr_b16 v[20:21], v5 offset:45824
    ds_read_b64_tr_b16 v[22:23], v5 offset:46400
    ds_read_b64_tr_b16 v[24:25], v5 offset:50432
    ds_read_b64_tr_b16 v[26:27], v5 offset:51008
    ds_read_b64_tr_b16 v[28:29], v5 offset:55040
    ds_read_b64_tr_b16 v[30:31], v5 offset:55616
K_DRN5:
    s_waitcnt vmcnt(14)
    v_lshlrev_b32 v8, 16, v53
    v_dot2c_f32_bf16 v32, v104, v53
    v_dot2c_f32_bf16 v34, v105, v53
    v_dot2c_f32_bf16 v36, v106, v53
    v_dot2c_f32_bf16 v38, v107, v53
    v_dot2c_f32_bf16 v40, v108, v53
    v_dot2c_f32_bf16 v42, v109, v53
    v_dot2c_f32_bf16 v44, v110, v53
    v_dot2c_f32_bf16 v46, v111, v53
    v_dot2c_f32_bf16 v33, v104, v8
    v_dot2c_f32_bf16 v35, v105, v8
    v_dot2c_f32_bf16 v37, v106, v8
    v_dot2c_f32_bf16 v39, v107, v8
    v_dot2c_f32_bf16 v41, v108, v8
    v_dot2c_f32_bf16 v43, v109, v8
    v_dot2c_f32_bf16 v45, v110, v8
    v_dot2c_f32_bf16 v47, v111, v8
    s_waitcnt vmcnt(12)
    v_lshlrev_b32 v8, 16, v54
    v_dot2c_f32_bf16 v32, v112, v54
    v_dot2c_f32_bf16 v34, v113, v54
    v_dot2c_f32_bf16 v36, v114, v54
    v_dot2c_f32_bf16 v38, v115, v54
    v_dot2c_f32_bf16 v40, v116, v54
    v_dot2c_f32_bf16 v42, v117, v54
    v_dot2c_f32_bf16 v44, v118, v54
    v_dot2c_f32_bf16 v46, v119, v54
    v_dot2c_f32_bf16 v33, v112, v8
    v_dot2c_f32_bf16 v35, v113, v8
    v_dot2c_f32_bf16 v37, v114, v8
    v_dot2c_f32_bf16 v39, v115, v8
    v_dot2c_f32_bf16 v41, v116, v8
    v_dot2c_f32_bf16 v43, v117, v8
    v_dot2c_f32_bf16 v45, v118, v8
    v_dot2c_f32_bf16 v47, v119, v8
    s_waitcnt vmcnt(10)
    v_lshlrev_b32 v8, 16, v55
    v_dot2c_f32_bf16 v32, v120, v55
    v_dot2c_f32_bf16 v34, v121, v55
    v_dot2c_f32_bf16 v36, v122, v55
    v_dot2c_f32_bf16 v38, v123, v55
    v_dot2c_f32_bf16 v40, v124, v55
    v_dot2c_f32_bf16 v42, v125, v55
    v_dot2c_f32_bf16 v44, v126, v55
    v_dot2c_f32_bf16 v46, v127, v55
    v_dot2c_f32_bf16 v33, v120, v8
    v_dot2c_f32_bf16 v35, v121, v8
    v_dot2c_f32_bf16 v37, v122, v8
    v_dot2c_f32_bf16 v39, v123, v8
    v_dot2c_f32_bf16 v41, v124, v8
    v_dot2c_f32_bf16 v43, v125, v8
    v_dot2c_f32_bf16 v45, v126, v8
    v_dot2c_f32_bf16 v47, v127, v8
    s_waitcnt vmcnt(8)
    v_lshlrev_b32 v8, 16, v48
    v_dot2c_f32_bf16 v32, v64, v48
    v_dot2c_f32_bf16 v34, v65, v48
    v_dot2c_f32_bf16 v36, v66, v48
    v_dot2c_f32_bf16 v38, v67, v48
    v_dot2c_f32_bf16 v40, v68, v48
    v_dot2c_f32_bf16 v42, v69, v48
    v_dot2c_f32_bf16 v44, v70, v48
    v_dot2c_f32_bf16 v46, v71, v48
    v_dot2c_f32_bf16 v33, v64, v8
    v_dot2c_f32_bf16 v35, v65, v8
    v_dot2c_f32_bf16 v37, v66, v8
    v_dot2c_f32_bf16 v39, v67, v8
    v_dot2c_f32_bf16 v41, v68, v8
    v_dot2c_f32_bf16 v43, v69, v8
    v_dot2c_f32_bf16 v45, v70, v8
    v_dot2c_f32_bf16 v47, v71, v8
    s_waitcnt vmcnt(6)
    v_lshlrev_b32 v8, 16, v49
    v_dot2c_f32_bf16 v32, v72, v49
    v_dot2c_f32_bf16 v34, v73, v49
    v_dot2c_f32_bf16 v36, v74, v49
    v_dot2c_f32_bf16 v38, v75, v49
    v_dot2c_f32_bf16 v40, v76, v49
    v_dot2c_f32_bf16 v42, v77, v49
    v_dot2c_f32_bf16 v44, v78, v49
    v_dot2c_f32_bf16 v46, v79, v49
    v_dot2c_f32_bf16 v33, v72, v8
    v_dot2c_f32_bf16 v35, v73, v8
    v_dot2c_f32_bf16 v37, v74, v8
    v_dot2c_f32_bf16 v39, v75, v8
    v_dot2c_f32_bf16 v41, v76, v8
    v_dot2c_f32_bf16 v43, v77, v8
    v_dot2c_f32_bf16 v45, v78, v8
    v_dot2c_f32_bf16 v47, v79, v8
    s_waitcnt vmcnt(4)
    v_lshlrev_b32 v8, 16, v50
    v_dot2c_f32_bf16 v32, v80, v50
    v_dot2c_f32_bf16 v34, v81, v50
    v_dot2c_f32_bf16 v36, v82, v50
    v_dot2c_f32_bf16 v38, v83, v50
    v_dot2c_f32_bf16 v40, v84, v50
    v_dot2c_f32_bf16 v42, v85, v50
    v_dot2c_f32_bf16 v44, v86, v50
    v_dot2c_f32_bf16 v46, v87, v50
    v_dot2c_f32_bf16 v33, v80, v8
    v_dot2c_f32_bf16 v35, v81, v8
    v_dot2c_f32_bf16 v37, v82, v8
    v_dot2c_f32_bf16 v39, v83, v8
    v_dot2c_f32_bf16 v41, v84, v8
    v_dot2c_f32_bf16 v43, v85, v8
    v_dot2c_f32_bf16 v45, v86, v8
    v_dot2c_f32_bf16 v47, v87, v8
    s_waitcnt vmcnt(2)
    v_lshlrev_b32 v8, 16, v51
    v_dot2c_f32_bf16 v32, v88, v51
    v_dot2c_f32_bf16 v34, v89, v51
    v_dot2c_f32_bf16 v36, v90, v51
    v_dot2c_f32_bf16 v38, v91, v51
    v_dot2c_f32_bf16 v40, v92, v51
    v_dot2c_f32_bf16 v42, v93, v51
    v_dot2c_f32_bf16 v44, v94, v51
    v_dot2c_f32_bf16 v46, v95, v51
    v_dot2c_f32_bf16 v33, v88, v8
    v_dot2c_f32_bf16 v35, v89, v8
    v_dot2c_f32_bf16 v37, v90, v8
    v_dot2c_f32_bf16 v39, v91, v8
    v_dot2c_f32_bf16 v41, v92, v8
    v_dot2c_f32_bf16 v43, v93, v8
    v_dot2c_f32_bf16 v45, v94, v8
    v_dot2c_f32_bf16 v47, v95, v8
    s_waitcnt vmcnt(0)
    v_lshlrev_b32 v8, 16, v52
    v_dot2c_f32_bf16 v32, v96, v52
    v_dot2c_f32_bf16 v34, v97, v52
    v_dot2c_f32_bf16 v36, v98, v52
    v_dot2c_f32_bf16 v38, v99, v52
    v_dot2c_f32_bf16 v40, v100, v52
    v_dot2c_f32_bf16 v42, v101, v52
    v_dot2c_f32_bf16 v44, v102, v52
    v_dot2c_f32_bf16 v46, v103, v52
    v_dot2c_f32_bf16 v33, v96, v8
    v_dot2c_f32_bf16 v35, v97, v8
    v_dot2c_f32_bf16 v37, v98, v8
    v_dot2c_f32_bf16 v39, v99, v8
    v_dot2c_f32_bf16 v41, v100, v8
    v_dot2c_f32_bf16 v43, v101, v8
    v_dot2c_f32_bf16 v45, v102, v8
    v_dot2c_f32_bf16 v47, v103, v8
    s_branch K_GDONE
K_DR6:
    s_waitcnt lgkmcnt(0)
    s_or_b32 s30, s55, s57
    s_cbranch_scc1 K_DRN6
    s_mov_b32 s62, 0
K_RW6:
    ds_read_b32 v11, v15 offset:62488
    s_add_u32 s62, s62, 1
    s_waitcnt lgkmcnt(0)
    v_readfirstlane_b32 s63, v11
    s_cmp_ge_u32 s62, 200000
    s_cbranch_scc1 K_RW6_X
    s_cmp_lt_u32 s63, 14
    s_cbranch_scc1 K_RW6
K_RW6_X:
    ds_read_b64_tr_b16 v[16:17], v5 offset:41216
    ds_read_b64_tr_b16 v[18:19], v5 offset:41792
    ds_read_b64_tr_b16 v[20:21], v5 offset:45824
    ds_read_b64_tr_b16 v[22:23], v5 offset:46400
    ds_read_b64_tr_b16 v[24:25], v5 offset:50432
    ds_read_b64_tr_b16 v[26:27], v5 offset:51008
    ds_read_b64_tr_b16 v[28:29], v5 offset:55040
    ds_read_b64_tr_b16 v[30:31], v5 offset:55616
K_DRN6:
    s_waitcnt vmcnt(14)
    v_lshlrev_b32 v8, 16, v54
    v_dot2c_f32_bf16 v32, v112, v54
    v_dot2c_f32_bf16 v34, v113, v54
    v_dot2c_f32_bf16 v36, v114, v54
    v_dot2c_f32_bf16 v38, v115, v54
    v_dot2c_f32_bf16 v40, v116, v54
    v_dot2c_f32_bf16 v42, v117, v54
    v_dot2c_f32_bf16 v44, v118, v54
    v_dot2c_f32_bf16 v46, v119, v54
    v_dot2c_f32_bf16 v33, v112, v8
    v_dot2c_f32_bf16 v35, v113, v8
    v_dot2c_f32_bf16 v37, v114, v8
    v_dot2c_f32_bf16 v39, v115, v8
    v_dot2c_f32_bf16 v41, v116, v8
    v_dot2c_f32_bf16 v43, v117, v8
    v_dot2c_f32_bf16 v45, v118, v8
    v_dot2c_f32_bf16 v47, v119, v8
    s_waitcnt vmcnt(12)
    v_lshlrev_b32 v8, 16, v55
    v_dot2c_f32_bf16 v32, v120, v55
    v_dot2c_f32_bf16 v34, v121, v55
    v_dot2c_f32_bf16 v36, v122, v55
    v_dot2c_f32_bf16 v38, v123, v55
    v_dot2c_f32_bf16 v40, v124, v55
    v_dot2c_f32_bf16 v42, v125, v55
    v_dot2c_f32_bf16 v44, v126, v55
    v_dot2c_f32_bf16 v46, v127, v55
    v_dot2c_f32_bf16 v33, v120, v8
    v_dot2c_f32_bf16 v35, v121, v8
    v_dot2c_f32_bf16 v37, v122, v8
    v_dot2c_f32_bf16 v39, v123, v8
    v_dot2c_f32_bf16 v41, v124, v8
    v_dot2c_f32_bf16 v43, v125, v8
    v_dot2c_f32_bf16 v45, v126, v8
    v_dot2c_f32_bf16 v47, v127, v8
    s_waitcnt vmcnt(10)
    v_lshlrev_b32 v8, 16, v48
    v_dot2c_f32_bf16 v32, v64, v48
    v_dot2c_f32_bf16 v34, v65, v48
    v_dot2c_f32_bf16 v36, v66, v48
    v_dot2c_f32_bf16 v38, v67, v48
    v_dot2c_f32_bf16 v40, v68, v48
    v_dot2c_f32_bf16 v42, v69, v48
    v_dot2c_f32_bf16 v44, v70, v48
    v_dot2c_f32_bf16 v46, v71, v48
    v_dot2c_f32_bf16 v33, v64, v8
    v_dot2c_f32_bf16 v35, v65, v8
    v_dot2c_f32_bf16 v37, v66, v8
    v_dot2c_f32_bf16 v39, v67, v8
    v_dot2c_f32_bf16 v41, v68, v8
    v_dot2c_f32_bf16 v43, v69, v8
    v_dot2c_f32_bf16 v45, v70, v8
    v_dot2c_f32_bf16 v47, v71, v8
    s_waitcnt vmcnt(8)
    v_lshlrev_b32 v8, 16, v49
    v_dot2c_f32_bf16 v32, v72, v49
    v_dot2c_f32_bf16 v34, v73, v49
    v_dot2c_f32_bf16 v36, v74, v49
    v_dot2c_f32_bf16 v38, v75, v49
    v_dot2c_f32_bf16 v40, v76, v49
    v_dot2c_f32_bf16 v42, v77, v49
    v_dot2c_f32_bf16 v44, v78, v49
    v_dot2c_f32_bf16 v46, v79, v49
    v_dot2c_f32_bf16 v33, v72, v8
    v_dot2c_f32_bf16 v35, v73, v8
    v_dot2c_f32_bf16 v37, v74, v8
    v_dot2c_f32_bf16 v39, v75, v8
    v_dot2c_f32_bf16 v41, v76, v8
    v_dot2c_f32_bf16 v43, v77, v8
    v_dot2c_f32_bf16 v45, v78, v8
    v_dot2c_f32_bf16 v47, v79, v8
    s_waitcnt vmcnt(6)
    v_lshlrev_b32 v8, 16, v50
    v_dot2c_f32_bf16 v32, v80, v50
    v_dot2c_f32_bf16 v34, v81, v50
    v_dot2c_f32_bf16 v36, v82, v50
    v_dot2c_f32_bf16 v38, v83, v50
    v_dot2c_f32_bf16 v40, v84, v50
    v_dot2c_f32_bf16 v42, v85, v50
    v_dot2c_f32_bf16 v44, v86, v50
    v_dot2c_f32_bf16 v46, v87, v50
    v_dot2c_f32_bf16 v33, v80, v8
    v_dot2c_f32_bf16 v35, v81, v8
    v_dot2c_f32_bf16 v37, v82, v8
    v_dot2c_f32_bf16 v39, v83, v8
    v_dot2c_f32_bf16 v41, v84, v8
    v_dot2c_f32_bf16 v43, v85, v8
    v_dot2c_f32_bf16 v45, v86, v8
    v_dot2c_f32_bf16 v47, v87, v8
    s_waitcnt vmcnt(4)
    v_lshlrev_b32 v8, 16, v51
    v_dot2c_f32_bf16 v32, v88, v51
    v_dot2c_f32_bf16 v34, v89, v51
    v_dot2c_f32_bf16 v36, v90, v51
    v_dot2c_f32_bf16 v38, v91, v51
    v_dot2c_f32_bf16 v40, v92, v51
    v_dot2c_f32_bf16 v42, v93, v51
    v_dot2c_f32_bf16 v44, v94, v51
    v_dot2c_f32_bf16 v46, v95, v51
    v_dot2c_f32_bf16 v33, v88, v8
    v_dot2c_f32_bf16 v35, v89, v8
    v_dot2c_f32_bf16 v37, v90, v8
    v_dot2c_f32_bf16 v39, v91, v8
    v_dot2c_f32_bf16 v41, v92, v8
    v_dot2c_f32_bf16 v43, v93, v8
    v_dot2c_f32_bf16 v45, v94, v8
    v_dot2c_f32_bf16 v47, v95, v8
    s_waitcnt vmcnt(2)
    v_lshlrev_b32 v8, 16, v52
    v_dot2c_f32_bf16 v32, v96, v52
    v_dot2c_f32_bf16 v34, v97, v52
    v_dot2c_f32_bf16 v36, v98, v52
    v_dot2c_f32_bf16 v38, v99, v52
    v_dot2c_f32_bf16 v40, v100, v52
    v_dot2c_f32_bf16 v42, v101, v52
    v_dot2c_f32_bf16 v44, v102, v52
    v_dot2c_f32_bf16 v46, v103, v52
    v_dot2c_f32_bf16 v33, v96, v8
    v_dot2c_f32_bf16 v35, v97, v8
    v_dot2c_f32_bf16 v37, v98, v8
    v_dot2c_f32_bf16 v39, v99, v8
    v_dot2c_f32_bf16 v41, v100, v8
    v_dot2c_f32_bf16 v43, v101, v8
    v_dot2c_f32_bf16 v45, v102, v8
    v_dot2c_f32_bf16 v47, v103, v8
    s_waitcnt vmcnt(0)
    v_lshlrev_b32 v8, 16, v53
    v_dot2c_f32_bf16 v32, v104, v53
    v_dot2c_f32_bf16 v34, v105, v53
    v_dot2c_f32_bf16 v36, v106, v53
    v_dot2c_f32_bf16 v38, v107, v53
    v_dot2c_f32_bf16 v40, v108, v53
    v_dot2c_f32_bf16 v42, v109, v53
    v_dot2c_f32_bf16 v44, v110, v53
    v_dot2c_f32_bf16 v46, v111, v53
    v_dot2c_f32_bf16 v33, v104, v8
    v_dot2c_f32_bf16 v35, v105, v8
    v_dot2c_f32_bf16 v37, v106, v8
    v_dot2c_f32_bf16 v39, v107, v8
    v_dot2c_f32_bf16 v41, v108, v8
    v_dot2c_f32_bf16 v43, v109, v8
    v_dot2c_f32_bf16 v45, v110, v8
    v_dot2c_f32_bf16 v47, v111, v8
    s_branch K_GDONE
K_DR7:
    s_waitcnt lgkmcnt(0)
    s_or_b32 s30, s55, s57
    s_cbranch_scc1 K_DRN7
    s_mov_b32 s62, 0
K_RW7:
    ds_read_b32 v11, v15 offset:62488
    s_add_u32 s62, s62, 1
    s_waitcnt lgkmcnt(0)
    v_readfirstlane_b32 s63, v11
    s_cmp_ge_u32 s62, 200000
    s_cbranch_scc1 K_RW7_X
    s_cmp_lt_u32 s63, 14
    s_cbranch_scc1 K_RW7
K_RW7_X:
    ds_read_b64_tr_b16 v[16:17], v5 offset:41216
    ds_read_b64_tr_b16 v[18:19], v5 offset:41792
    ds_read_b64_tr_b16 v[20:21], v5 offset:45824
    ds_read_b64_tr_b16 v[22:23], v5 offset:46400
    ds_read_b64_tr_b16 v[24:25], v5 offset:50432
    ds_read_b64_tr_b16 v[26:27], v5 offset:51008
    ds_read_b64_tr_b16 v[28:29], v5 offset:55040
    ds_read_b64_tr_b16 v[30:31], v5 offset:55616
K_DRN7:
    s_waitcnt vmcnt(14)
    v_lshlrev_b32 v8, 16, v55
    v_dot2c_f32_bf16 v32, v120, v55
    v_dot2c_f32_bf16 v34, v121, v55
    v_dot2c_f32_bf16 v36, v122, v55
    v_dot2c_f32_bf16 v38, v123, v55
    v_dot2c_f32_bf16 v40, v124, v55
    v_dot2c_f32_bf16 v42, v125, v55
    v_dot2c_f32_bf16 v44, v126, v55
    v_dot2c_f32_bf16 v46, v127, v55
    v_dot2c_f32_bf16 v33, v120, v8
    v_dot2c_f32_bf16 v35, v121, v8
    v_dot2c_f32_bf16 v37, v122, v8
    v_dot2c_f32_bf16 v39, v123, v8
    v_dot2c_f32_bf16 v41, v124, v8
    v_dot2c_f32_bf16 v43, v125, v8
    v_dot2c_f32_bf16 v45, v126, v8
    v_dot2c_f32_bf16 v47, v127, v8
    s_waitcnt vmcnt(12)
    v_lshlrev_b32 v8, 16, v48
    v_dot2c_f32_bf16 v32, v64, v48
    v_dot2c_f32_bf16 v34, v65, v48
    v_dot2c_f32_bf16 v36, v66, v48
    v_dot2c_f32_bf16 v38, v67, v48
    v_dot2c_f32_bf16 v40, v68, v48
    v_dot2c_f32_bf16 v42, v69, v48
    v_dot2c_f32_bf16 v44, v70, v48
    v_dot2c_f32_bf16 v46, v71, v48
    v_dot2c_f32_bf16 v33, v64, v8
    v_dot2c_f32_bf16 v35, v65, v8
    v_dot2c_f32_bf16 v37, v66, v8
    v_dot2c_f32_bf16 v39, v67, v8
    v_dot2c_f32_bf16 v41, v68, v8
    v_dot2c_f32_bf16 v43, v69, v8
    v_dot2c_f32_bf16 v45, v70, v8
    v_dot2c_f32_bf16 v47, v71, v8
    s_waitcnt vmcnt(10)
    v_lshlrev_b32 v8, 16, v49
    v_dot2c_f32_bf16 v32, v72, v49
    v_dot2c_f32_bf16 v34, v73, v49
    v_dot2c_f32_bf16 v36, v74, v49
    v_dot2c_f32_bf16 v38, v75, v49
    v_dot2c_f32_bf16 v40, v76, v49
    v_dot2c_f32_bf16 v42, v77, v49
    v_dot2c_f32_bf16 v44, v78, v49
    v_dot2c_f32_bf16 v46, v79, v49
    v_dot2c_f32_bf16 v33, v72, v8
    v_dot2c_f32_bf16 v35, v73, v8
    v_dot2c_f32_bf16 v37, v74, v8
    v_dot2c_f32_bf16 v39, v75, v8
    v_dot2c_f32_bf16 v41, v76, v8
    v_dot2c_f32_bf16 v43, v77, v8
    v_dot2c_f32_bf16 v45, v78, v8
    v_dot2c_f32_bf16 v47, v79, v8
    s_waitcnt vmcnt(8)
    v_lshlrev_b32 v8, 16, v50
    v_dot2c_f32_bf16 v32, v80, v50
    v_dot2c_f32_bf16 v34, v81, v50
    v_dot2c_f32_bf16 v36, v82, v50
    v_dot2c_f32_bf16 v38, v83, v50
    v_dot2c_f32_bf16 v40, v84, v50
    v_dot2c_f32_bf16 v42, v85, v50
    v_dot2c_f32_bf16 v44, v86, v50
    v_dot2c_f32_bf16 v46, v87, v50
    v_dot2c_f32_bf16 v33, v80, v8
    v_dot2c_f32_bf16 v35, v81, v8
    v_dot2c_f32_bf16 v37, v82, v8
    v_dot2c_f32_bf16 v39, v83, v8
    v_dot2c_f32_bf16 v41, v84, v8
    v_dot2c_f32_bf16 v43, v85, v8
    v_dot2c_f32_bf16 v45, v86, v8
    v_dot2c_f32_bf16 v47, v87, v8
    s_waitcnt vmcnt(6)
    v_lshlrev_b32 v8, 16, v51
    v_dot2c_f32_bf16 v32, v88, v51
    v_dot2c_f32_bf16 v34, v89, v51
    v_dot2c_f32_bf16 v36, v90, v51
    v_dot2c_f32_bf16 v38, v91, v51
    v_dot2c_f32_bf16 v40, v92, v51
    v_dot2c_f32_bf16 v42, v93, v51
    v_dot2c_f32_bf16 v44, v94, v51
    v_dot2c_f32_bf16 v46, v95, v51
    v_dot2c_f32_bf16 v33, v88, v8
    v_dot2c_f32_bf16 v35, v89, v8
    v_dot2c_f32_bf16 v37, v90, v8
    v_dot2c_f32_bf16 v39, v91, v8
    v_dot2c_f32_bf16 v41, v92, v8
    v_dot2c_f32_bf16 v43, v93, v8
    v_dot2c_f32_bf16 v45, v94, v8
    v_dot2c_f32_bf16 v47, v95, v8
    s_waitcnt vmcnt(4)
    v_lshlrev_b32 v8, 16, v52
    v_dot2c_f32_bf16 v32, v96, v52
    v_dot2c_f32_bf16 v34, v97, v52
    v_dot2c_f32_bf16 v36, v98, v52
    v_dot2c_f32_bf16 v38, v99, v52
    v_dot2c_f32_bf16 v40, v100, v52
    v_dot2c_f32_bf16 v42, v101, v52
    v_dot2c_f32_bf16 v44, v102, v52
    v_dot2c_f32_bf16 v46, v103, v52
    v_dot2c_f32_bf16 v33, v96, v8
    v_dot2c_f32_bf16 v35, v97, v8
    v_dot2c_f32_bf16 v37, v98, v8
    v_dot2c_f32_bf16 v39, v99, v8
    v_dot2c_f32_bf16 v41, v100, v8
    v_dot2c_f32_bf16 v43, v101, v8
    v_dot2c_f32_bf16 v45, v102, v8
    v_dot2c_f32_bf16 v47, v103, v8
    s_waitcnt vmcnt(2)
    v_lshlrev_b32 v8, 16, v53
    v_dot2c_f32_bf16 v32, v104, v53
    v_dot2c_f32_bf16 v34, v105, v53
    v_dot2c_f32_bf16 v36, v106, v53
    v_dot2c_f32_bf16 v38, v107, v53
    v_dot2c_f32_bf16 v40, v108, v53
    v_dot2c_f32_bf16 v42, v109, v53
    v_dot2c_f32_bf16 v44, v110, v53
    v_dot2c_f32_bf16 v46, v111, v53
    v_dot2c_f32_bf16 v33, v104, v8
    v_dot2c_f32_bf16 v35, v105, v8
    v_dot2c_f32_bf16 v37, v106, v8
    v_dot2c_f32_bf16 v39, v107, v8
    v_dot2c_f32_bf16 v41, v108, v8
    v_dot2c_f32_bf16 v43, v109, v8
    v_dot2c_f32_bf16 v45, v110, v8
    v_dot2c_f32_bf16 v47, v111, v8
    s_waitcnt vmcnt(0)
    v_lshlrev_b32 v8, 16, v54
    v_dot2c_f32_bf16 v32, v112, v54
    v_dot2c_f32_bf16 v34, v113, v54
    v_dot2c_f32_bf16 v36, v114, v54
    v_dot2c_f32_bf16 v38, v115, v54
    v_dot2c_f32_bf16 v40, v116, v54
    v_dot2c_f32_bf16 v42, v117, v54
    v_dot2c_f32_bf16 v44, v118, v54
    v_dot2c_f32_bf16 v46, v119, v54
    v_dot2c_f32_bf16 v33, v112, v8
    v_dot2c_f32_bf16 v35, v113, v8
    v_dot2c_f32_bf16 v37, v114, v8
    v_dot2c_f32_bf16 v39, v115, v8
    v_dot2c_f32_bf16 v41, v116, v8
    v_dot2c_f32_bf16 v43, v117, v8
    v_dot2c_f32_bf16 v45, v118, v8
    v_dot2c_f32_bf16 v47, v119, v8
    s_branch K_GDONE
K_HMAIN:
    s_cmp_lg_u32 s56, 0
    s_cbranch_scc1 K_GDONE
    s_setprio 3
    v_lshrrev_b32 v8, 3, v1
    v_and_b32 v9, 7, v1
    v_xor_b32 v9, v9, v8
    v_lshlrev_b32 v8, 7, v8
    v_lshl_add_u32 v59, v9, 4, v8
    s_mul_i32 s62, s2, 25088
    s_sub_u32 s63, s3, 13
    s_lshl_b32 s63, s63, 11
    s_add_u32 s62, s62, s63
    s_add_u32 s63, s63, 15872
    s_mov_b32 m0, s63
    s_add_u32 s64, s62, 1024
    buffer_load_dwordx4 v59, s[32:35], s62 offen lds
    s_add_u32 m0, s63, 1024
    s_add_u32 s62, s62, 6144
    buffer_load_dwordx4 v59, s[32:35], s64 offen lds
    s_add_u32 s63, s63, 6144
    s_mov_b32 m0, s63
    s_add_u32 s64, s62, 1024
    buffer_load_dwordx4 v59, s[32:35], s62 offen lds
    s_add_u32 m0, s63, 1024
    s_add_u32 s62, s62, 6144
    buffer_load_dwordx4 v59, s[32:35], s64 offen lds
    s_add_u32 s63, s63, 6144
    s_mov_b32 m0, s63
    s_add_u32 s64, s62, 1024
    buffer_load_dwordx4 v59, s[32:35], s62 offen lds
    s_add_u32 m0, s63, 1024
    s_add_u32 s62, s62, 6144
    buffer_load_dwordx4 v59, s[32:35], s64 offen lds
    s_add_u32 s63, s63, 6144
    s_mov_b32 m0, s63
    s_add_u32 s64, s62, 1024
    buffer_load_dwordx4 v59, s[32:35], s62 offen lds
    s_add_u32 m0, s63, 1024
    s_add_u32 s62, s62, 6144
    buffer_load_dwordx4 v59, s[32:35], s64 offen lds
    s_add_u32 s63, s63, 6144
    s_cmp_lg_u32 s3, 13
    s_cbranch_scc1 K_XOXd
    s_mov_b32 m0, s63
    v_cmpx_gt_u32 vcc, 40, v1
    buffer_load_dwordx4 v59, s[32:35], s62 offen lds
    s_mov_b64 exec, -1
K_XOXd:
    v_and_b32 v9, 15, v0
    v_lshrrev_b32 v10, 4, v1
    v_and_b32 v6, 7, v9
    v_xor_b32 v6, v6, v10
    v_lshlrev_b32 v6, 4, v6
    v_lshl_add_u32 v6, v9, 7, v6
    s_sub_u32 s62, s3, 13
    s_lshl_b32 s30, s62, 11
    v_add_u32 v6, s30, v6
    v_xor_b32 v59, 64, v6
    s_lshl_b32 s30, s62, 2
    v_mov_b32 v8, s30
    s_waitcnt vmcnt(0)
K_QLOOP:
    ds_read_b128 v[24:27], v6 offset:15872
    ds_read_b128 v[28:31], v59 offset:15872
    s_waitcnt lgkmcnt(0)
    v_mfma_f32_16x16x32_bf16 v[32:35], v[64:67], v[24:27], 0
    v_mfma_f32_16x16x32_bf16 v[36:39], v[72:75], v[24:27], 0
    v_mfma_f32_16x16x32_bf16 v[40:43], v[80:83], v[24:27], 0
    v_mfma_f32_16x16x32_bf16 v[44:47], v[88:91], v[24:27], 0
    v_mfma_f32_16x16x32_bf16 v[32:35], v[68:71], v[28:31], v[32:35]
    v_mfma_f32_16x16x32_bf16 v[36:39], v[76:79], v[28:31], v[36:39]
    v_mfma_f32_16x16x32_bf16 v[40:43], v[84:87], v[28:31], v[40:43]
    v_mfma_f32_16x16x32_bf16 v[44:47], v[92:95], v[28:31], v[44:47]
    s_nop 4
    v_cvt_pk_bf16_f32 v48, v32, v33
    v_cvt_pk_bf16_f32 v49, v34, v35
    v_cvt_pk_bf16_f32 v50, v36, v37
    v_cvt_pk_bf16_f32 v51, v38, v39
    v_cvt_pk_bf16_f32 v52, v40, v41
    v_cvt_pk_bf16_f32 v53, v42, v43
    v_cvt_pk_bf16_f32 v54, v44, v45
    v_cvt_pk_bf16_f32 v55, v46, v47
    s_nop 1
    v_mfma_f32_16x16x32_bf16 v[32:35], v[96:99], v[48:51], 0
    v_mfma_f32_16x16x32_bf16 v[36:39], v[104:107], v[48:51], 0
    v_mfma_f32_16x16x32_bf16 v[40:43], v[112:115], v[48:51], 0
    v_mfma_f32_16x16x32_bf16 v[44:47], v[120:123], v[48:51], 0
    v_mfma_f32_16x16x32_bf16 v[32:35], v[100:103], v[52:55], v[32:35]
    v_mfma_f32_16x16x32_bf16 v[36:39], v[108:111], v[52:55], v[36:39]
    v_mfma_f32_16x16x32_bf16 v[40:43], v[116:119], v[52:55], v[40:43]
    v_mfma_f32_16x16x32_bf16 v[44:47], v[124:127], v[52:55], v[44:47]
    s_nop 4
    v_cvt_pk_bf16_f32 v24, v32, v33
    v_cvt_pk_bf16_f32 v25, v34, v35
    v_cvt_pk_bf16_f32 v26, v36, v37
    v_cvt_pk_bf16_f32 v27, v38, v39
    v_cvt_pk_bf16_f32 v28, v40, v41
    v_cvt_pk_bf16_f32 v29, v42, v43
    v_cvt_pk_bf16_f32 v30, v44, v45
    v_cvt_pk_bf16_f32 v31, v46, v47
    s_cmp_lg_u32 s62, 12
    s_cbranch_scc1 K_QW2
    v_cmpx_gt_u32 vcc, 5, v9
K_QW2:
    ds_write_b128 v6, v[24:27] offset:15872
    ds_write_b128 v59, v[28:31] offset:15872
    s_mov_b64 exec, -1
    v_add_u32 v6, 6144, v6
    v_add_u32 v59, 6144, v59
    s_add_u32 s62, s62, 3
    s_waitcnt lgkmcnt(0)
    ds_write_b32 v8, v12 offset:62432
    v_add_u32 v8, 12, v8
    s_cmp_lt_u32 s62, 13
    s_cbranch_scc1 K_QLOOP
    s_cmp_lg_u32 s3, 15
    s_cbranch_scc1 K_GDONE
    v_lshlrev_b32 v11, 4, v1
    global_load_dwordx4 v[64:67], v11, s[16:17] offset:0
    global_load_dwordx4 v[68:71], v11, s[16:17] offset:1024
    global_load_dwordx4 v[72:75], v11, s[16:17] offset:2048
    global_load_dwordx4 v[76:79], v11, s[16:17] offset:3072
    v_add_u32 v11, 0x1000, v11
    global_load_dwordx4 v[80:83], v11, s[16:17] offset:0
    global_load_dwordx4 v[84:87], v11, s[16:17] offset:1024
    global_load_dwordx4 v[88:91], v11, s[16:17] offset:2048
    global_load_dwordx4 v[92:95], v11, s[16:17] offset:3072
    v_add_u32 v11, 0xfffff000, v11
    global_load_dwordx4 v[96:99], v11, s[22:23] offset:0
    global_load_dwordx4 v[100:103], v11, s[22:23] offset:1024
    global_load_dwordx4 v[104:107], v11, s[22:23] offset:2048
    global_load_dwordx4 v[108:111], v11, s[22:23] offset:3072
    v_add_u32 v11, 0x1000, v11
    global_load_dwordx4 v[112:115], v11, s[22:23] offset:0
    global_load_dwordx4 v[116:119], v11, s[22:23] offset:1024
    global_load_dwordx4 v[120:123], v11, s[22:23] offset:2048
    global_load_dwordx4 v[124:127], v11, s[22:23] offset:3072
    s_waitcnt vmcnt(0)
    v_lshrrev_b32 v8, 3, v1
    v_mul_u32_u24 v8, 144, v8
    v_and_b32 v9, 7, v1
    v_lshl_add_u32 v8, v9, 4, v8
    ds_write_b128 v8, v[64:67] offset:41216
    ds_write_b128 v8, v[68:71] offset:42368
    ds_write_b128 v8, v[72:75] offset:43520
    ds_write_b128 v8, v[76:79] offset:44672
    ds_write_b128 v8, v[80:83] offset:45824
    ds_write_b128 v8, v[84:87] offset:46976
    ds_write_b128 v8, v[88:91] offset:48128
    ds_write_b128 v8, v[92:95] offset:49280
    ds_write_b128 v8, v[96:99] offset:50432
    ds_write_b128 v8, v[100:103] offset:51584
    ds_write_b128 v8, v[104:107] offset:52736
    ds_write_b128 v8, v[108:111] offset:53888
    ds_write_b128 v8, v[112:115] offset:55040
    ds_write_b128 v8, v[116:119] offset:56192
    ds_write_b128 v8, v[120:123] offset:57344
    ds_write_b128 v8, v[124:127] offset:58496
    s_waitcnt lgkmcnt(0)
    v_cmpx_eq_u32 vcc, 0, v1
    ds_add_u32 v15, v12 offset:62488
    s_mov_b64 exec, -1
K_GDONE:
    s_setprio 3
    s_or_b32 s30, s55, s57
    s_cbranch_scc1 K_RARE
K_EPI:
    s_cmp_ge_u32 s3, 13
    s_cbranch_scc1 K_END
    s_cmp_lg_u32 s3, 0
    s_cbranch_scc1 K_NOCOMB
    v_add_f32_dpp v32, v32, v32 row_shl:4 row_mask:0xf bank_mask:0xf
    v_add_f32_dpp v33, v33, v33 row_shl:4 row_mask:0xf bank_mask:0xf
    v_add_f32_dpp v34, v34, v34 row_shl:4 row_mask:0xf bank_mask:0xf
    v_add_f32_dpp v35, v35, v35 row_shl:4 row_mask:0xf bank_mask:0xf
    v_add_f32_dpp v36, v36, v36 row_shl:4 row_mask:0xf bank_mask:0xf
    v_add_f32_dpp v37, v37, v37 row_shl:4 row_mask:0xf bank_mask:0xf
    v_add_f32_dpp v38, v38, v38 row_shl:4 row_mask:0xf bank_mask:0xf
    v_add_f32_dpp v39, v39, v39 row_shl:4 row_mask:0xf bank_mask:0xf
    v_add_f32_dpp v40, v40, v40 row_shl:4 row_mask:0xf bank_mask:0xf
    v_add_f32_dpp v41, v41, v41 row_shl:4 row_mask:0xf bank_mask:0xf
    v_add_f32_dpp v42, v42, v42 row_shl:4 row_mask:0xf bank_mask:0xf
    v_add_f32_dpp v43, v43, v43 row_shl:4 row_mask:0xf bank_mask:0xf
    v_add_f32_dpp v44, v44, v44 row_shl:4 row_mask:0xf bank_mask:0xf
    v_add_f32_dpp v45, v45, v45 row_shl:4 row_mask:0xf bank_mask:0xf
    v_add_f32_dpp v46, v46, v46 row_shl:4 row_mask:0xf bank_mask:0xf
    v_add_f32_dpp v47, v47, v47 row_shl:4 row_mask:0xf bank_mask:0xf
K_NOCOMB:
    s_cmp_eq_u32 s56, 0
    s_cbranch_scc1 K_HAVEF
    s_mov_b32 s62, 0
K_RW:
    ds_read_b32 v11, v15 offset:62488
    s_add_u32 s62, s62, 1
    s_waitcnt lgkmcnt(0)
    v_readfirstlane_b32 s63, v11
    s_cmp_ge_u32 s62, 200000
    s_cbranch_scc1 K_RW_X
    s_cmp_lt_u32 s63, 14
    s_cbranch_scc1 K_RW
K_RW_X:
    ds_read_b64_tr_b16 v[16:17], v5 offset:41216
    ds_read_b64_tr_b16 v[18:19], v5 offset:41792
    ds_read_b64_tr_b16 v[20:21], v5 offset:45824
    ds_read_b64_tr_b16 v[22:23], v5 offset:46400
    ds_read_b64_tr_b16 v[24:25], v5 offset:50432
    ds_read_b64_tr_b16 v[26:27], v5 offset:51008
    ds_read_b64_tr_b16 v[28:29], v5 offset:55040
    ds_read_b64_tr_b16 v[30:31], v5 offset:55616
K_HAVEF:
    v_xor_b32 v11, 64, v61
    ds_read_b128 v[80:83], v61 offset:15872
    ds_read_b128 v[84:87], v11 offset:15872
    v_mul_f32 v32, v32, v60
    v_mul_f32 v33, v33, v60
    v_mul_f32 v34, v34, v60
    v_mul_f32 v35, v35, v60
    v_mul_f32 v36, v36, v60
    v_mul_f32 v37, v37, v60
    v_mul_f32 v38, v38, v60
    v_mul_f32 v39, v39, v60
    v_mul_f32 v40, v40, v60
    v_mul_f32 v41, v41, v60
    v_mul_f32 v42, v42, v60
    v_mul_f32 v43, v43, v60
    v_mul_f32 v44, v44, v60
    v_mul_f32 v45, v45, v60
    v_mul_f32 v46, v46, v60
    v_mul_f32 v47, v47, v60
    v_cvt_pk_bf16_f32 v64, v32, v33
    v_cvt_pk_bf16_f32 v65, v34, v35
    v_cvt_pk_bf16_f32 v66, v36, v37
    v_cvt_pk_bf16_f32 v67, v38, v39
    v_cvt_pk_bf16_f32 v68, v40, v41
    v_cvt_pk_bf16_f32 v69, v42, v43
    v_cvt_pk_bf16_f32 v70, v44, v45
    v_cvt_pk_bf16_f32 v71, v46, v47
    ds_bpermute_b32 v72, v3, v64
    ds_bpermute_b32 v73, v3, v65
    ds_bpermute_b32 v74, v3, v66
    ds_bpermute_b32 v75, v3, v67
    ds_bpermute_b32 v76, v3, v68
    ds_bpermute_b32 v77, v3, v69
    ds_bpermute_b32 v78, v3, v70
    ds_bpermute_b32 v79, v3, v71
    s_mov_b32 s36, s24
    s_mov_b32 s37, s25
    s_mov_b32 s38, 6400000
    s_mov_b32 s39, 0x20000
    ds_read_b64_tr_b16 v[104:105], v5 offset:41224
    ds_read_b64_tr_b16 v[106:107], v5 offset:41800
    ds_read_b64_tr_b16 v[108:109], v5 offset:45832
    ds_read_b64_tr_b16 v[110:111], v5 offset:46408
    ds_read_b64_tr_b16 v[112:113], v5 offset:50440
    ds_read_b64_tr_b16 v[114:115], v5 offset:51016
    ds_read_b64_tr_b16 v[116:117], v5 offset:55048
    ds_read_b64_tr_b16 v[118:119], v5 offset:55624
    s_waitcnt lgkmcnt(8)
    v_mfma_f32_16x16x32_bf16 v[88:91], v[24:27], v[80:83], 0
    v_mfma_f32_16x16x32_bf16 v[88:91], v[28:31], v[84:87], v[88:91]
    v_mfma_f32_16x16x32_bf16 v[88:91], v[16:19], v[72:75], v[88:91]
    v_mfma_f32_16x16x32_bf16 v[88:91], v[20:23], v[76:79], v[88:91]
    ds_read_b64_tr_b16 v[16:17], v5 offset:41280
    ds_read_b64_tr_b16 v[18:19], v5 offset:41856
    ds_read_b64_tr_b16 v[20:21], v5 offset:45888
    ds_read_b64_tr_b16 v[22:23], v5 offset:46464
    ds_read_b64_tr_b16 v[24:25], v5 offset:50496
    ds_read_b64_tr_b16 v[26:27], v5 offset:51072
    ds_read_b64_tr_b16 v[28:29], v5 offset:55104
    ds_read_b64_tr_b16 v[30:31], v5 offset:55680
    s_waitcnt lgkmcnt(8)
    v_mfma_f32_16x16x32_bf16 v[92:95], v[112:115], v[80:83], 0
    v_mfma_f32_16x16x32_bf16 v[92:95], v[116:119], v[84:87], v[92:95]
    v_mfma_f32_16x16x32_bf16 v[92:95], v[104:107], v[72:75], v[92:95]
    v_mfma_f32_16x16x32_bf16 v[92:95], v[108:111], v[76:79], v[92:95]
    ds_read_b64_tr_b16 v[104:105], v5 offset:41288
    ds_read_b64_tr_b16 v[106:107], v5 offset:41864
    ds_read_b64_tr_b16 v[108:109], v5 offset:45896
    ds_read_b64_tr_b16 v[110:111], v5 offset:46472
    ds_read_b64_tr_b16 v[112:113], v5 offset:50504
    ds_read_b64_tr_b16 v[114:115], v5 offset:51080
    ds_read_b64_tr_b16 v[116:117], v5 offset:55112
    ds_read_b64_tr_b16 v[118:119], v5 offset:55688
    s_waitcnt lgkmcnt(8)
    v_mfma_f32_16x16x32_bf16 v[96:99], v[24:27], v[80:83], 0
    v_mfma_f32_16x16x32_bf16 v[96:99], v[28:31], v[84:87], v[96:99]
    v_mfma_f32_16x16x32_bf16 v[96:99], v[16:19], v[72:75], v[96:99]
    v_mfma_f32_16x16x32_bf16 v[96:99], v[20:23], v[76:79], v[96:99]
    s_waitcnt lgkmcnt(0)
    v_mfma_f32_16x16x32_bf16 v[100:103], v[112:115], v[80:83], 0
    v_mfma_f32_16x16x32_bf16 v[100:103], v[116:119], v[84:87], v[100:103]
    v_mfma_f32_16x16x32_bf16 v[100:103], v[104:107], v[72:75], v[100:103]
    v_mfma_f32_16x16x32_bf16 v[100:103], v[108:111], v[76:79], v[100:103]
    v_cvt_pk_bf16_f32 v64, v88, v89
    v_cvt_pk_bf16_f32 v65, v90, v91
    v_cvt_pk_bf16_f32 v66, v92, v93
    v_cvt_pk_bf16_f32 v67, v94, v95
    ds_bpermute_b32 v16, v4, v64
    ds_bpermute_b32 v17, v4, v65
    ds_bpermute_b32 v18, v4, v66
    ds_bpermute_b32 v19, v4, v67
    v_cvt_pk_bf16_f32 v68, v96, v97
    v_cvt_pk_bf16_f32 v69, v98, v99
    v_cvt_pk_bf16_f32 v70, v100, v101
    v_cvt_pk_bf16_f32 v71, v102, v103
    ds_bpermute_b32 v20, v4, v68
    ds_bpermute_b32 v21, v4, v69
    ds_bpermute_b32 v22, v4, v70
    ds_bpermute_b32 v23, v4, v71
    s_waitcnt lgkmcnt(4)
    buffer_store_dwordx4 v[16:19], v62, s[36:39], 0 offen sc1
    s_waitcnt lgkmcnt(0)
    buffer_store_dwordx4 v[20:23], v62, s[36:39], 0 offen offset:64 sc1
K_END:
    s_endpgm
K_AOVF:
    v_cmpx_le_u32 vcc, 32, v80
    s_cbranch_execz K_AOVF_S0
    ds_add_rtn_u32 v8, v15, v12 offset:61696
    v_lshlrev_b32 v9, 24, v72
    v_or_b32 v9, v9, v76
    s_mul_i32 s30, s2, 12544
    s_add_u32 s30, s30, 8454144
    s_waitcnt lgkmcnt(0)
    v_lshlrev_b32 v8, 2, v8
    v_add_u32 v8, s30, v8
    global_store_dword v8, v9, s[28:29] sc1
K_AOVF_S0:
    s_mov_b64 exec, -1
    v_cmpx_le_u32 vcc, 32, v81
    s_cbranch_execz K_AOVF_S1
    ds_add_rtn_u32 v8, v15, v12 offset:61696
    v_lshlrev_b32 v9, 24, v73
    v_or_b32 v9, v9, v77
    s_mul_i32 s30, s2, 12544
    s_add_u32 s30, s30, 8454144
    s_waitcnt lgkmcnt(0)
    v_lshlrev_b32 v8, 2, v8
    v_add_u32 v8, s30, v8
    global_store_dword v8, v9, s[28:29] sc1
K_AOVF_S1:
    s_mov_b64 exec, -1
    v_cmpx_le_u32 vcc, 32, v82
    s_cbranch_execz K_AOVF_S2
    ds_add_rtn_u32 v8, v15, v12 offset:61696
    v_lshlrev_b32 v9, 24, v74
    v_or_b32 v9, v9, v78
    s_mul_i32 s30, s2, 12544
    s_add_u32 s30, s30, 8454144
    s_waitcnt lgkmcnt(0)
    v_lshlrev_b32 v8, 2, v8
    v_add_u32 v8, s30, v8
    global_store_dword v8, v9, s[28:29] sc1
K_AOVF_S2:
    s_mov_b64 exec, -1
    s_mov_b64 exec, s[60:61]
    v_cmpx_le_u32 vcc, 32, v83
    s_cbranch_execz K_AOVF_S3
    ds_add_rtn_u32 v8, v15, v12 offset:61696
    v_lshlrev_b32 v9, 24, v75
    v_or_b32 v9, v9, v79
    s_mul_i32 s30, s2, 12544
    s_add_u32 s30, s30, 8454144
    s_waitcnt lgkmcnt(0)
    v_lshlrev_b32 v8, 2, v8
    v_add_u32 v8, s30, v8
    global_store_dword v8, v9, s[28:29] sc1
K_AOVF_S3:
    s_mov_b64 exec, -1
    s_waitcnt vmcnt(0)
    s_branch K_AOVF_RET
K_AOVF2:
    v_or_b32 v48, v53, v48
    v_or_b32 v49, v53, v49
    v_or_b32 v50, v53, v50
    v_or_b32 v51, v53, v51
    v_lshrrev_b32 v8, 3, v0
    v_lshlrev_b32 v8, 2, v8
    ds_read_b32 v54, v8 offset:60672
    ds_read_b32 v55, v8 offset:61184
    s_waitcnt lgkmcnt(0)
    v_cmp_lt_u32 vcc, 32, v54
    v_mov_b32 v56, 0x01000000
    s_nop 0
    v_cndmask_b32 v54, 0, v56, vcc
    v_or_b32 v44, v54, v44
    v_or_b32 v45, v54, v45
    v_or_b32 v46, v54, v46
    v_or_b32 v47, v54, v47
    v_cmp_lt_u32 vcc, 32, v55
    v_mov_b32 v56, 0x01000000
    s_nop 0
    v_cndmask_b32 v55, 0, v56, vcc
    v_or_b32 v48, v55, v48
    v_or_b32 v49, v55, v49
    v_or_b32 v50, v55, v50
    v_or_b32 v51, v55, v51
    v_cmp_eq_u32 vcc, 0, v0
    s_and_saveexec_b64 s[30:31], vcc
    s_cbranch_execz K_AOVF2_X
    v_or_b32 v52, v53, v52
    s_lshl_b32 s62, s2, 2
    s_add_u32 s62, s62, 4096
    v_mov_b32 v54, s62
    global_store_dword v54, v52, s[28:29] sc1
K_AOVF2_X:
    s_mov_b64 exec, s[30:31]
    global_store_dwordx4 v30, v[44:47], s[28:29] sc1
    s_branch K_AOVF2_RET
K_POLLSLOW:
    s_mov_b32 s62, 0
K_PS_LOOP:
    v_xor_b32_sdwa v32, v16, s49 dst_sel:DWORD dst_unused:UNUSED_PAD src0_sel:BYTE_3 src1_sel:DWORD
    v_xor_b32_sdwa v33, v17, s49 dst_sel:DWORD dst_unused:UNUSED_PAD src0_sel:BYTE_3 src1_sel:DWORD
    v_xor_b32_sdwa v34, v18, s49 dst_sel:DWORD dst_unused:UNUSED_PAD src0_sel:BYTE_3 src1_sel:DWORD
    v_xor_b32_sdwa v35, v19, s49 dst_sel:DWORD dst_unused:UNUSED_PAD src0_sel:BYTE_3 src1_sel:DWORD
    v_xor_b32_sdwa v36, v20, s49 dst_sel:DWORD dst_unused:UNUSED_PAD src0_sel:BYTE_3 src1_sel:DWORD
    v_xor_b32_sdwa v37, v21, s49 dst_sel:DWORD dst_unused:UNUSED_PAD src0_sel:BYTE_3 src1_sel:DWORD
    v_xor_b32_sdwa v38, v22, s49 dst_sel:DWORD dst_unused:UNUSED_PAD src0_sel:BYTE_3 src1_sel:DWORD
    v_xor_b32_sdwa v39, v23, s49 dst_sel:DWORD dst_unused:UNUSED_PAD src0_sel:BYTE_3 src1_sel:DWORD
    v_max3_u32 v8, v32, v33, v34
    v_max3_u32 v9, v35, v36, v37
    v_max3_u32 v8, v8, v38, v39
    v_max_u32 v8, v8, v9
    s_nop 1
    v_max_u32_dpp v8, v8, v8 quad_perm:[1,0,3,2] row_mask:0xf bank_mask:0xf
    s_nop 1
    v_max_u32_dpp v8, v8, v8 quad_perm:[2,3,0,1] row_mask:0xf bank_mask:0xf
    v_cmp_lt_u32 vcc, 1, v8
    s_cbranch_vccz K_PS_OK
    s_add_u32 s62, s62, 1
    s_cmp_ge_u32 s62, 200000
    s_cbranch_scc1 K_PS_OK
    s_mov_b64 exec, vcc
    global_load_dwordx4 v[16:19], v7, s[28:29] sc1
    global_load_dwordx4 v[20:23], v7, s[28:29] offset:64 sc1
    s_mov_b64 exec, -1
    s_waitcnt vmcnt(0)
    v_mov_b32 v10, s48
    v_mov_b32_dpp v8, v19 quad_perm:[3,3,3,3] row_mask:0xf bank_mask:0xf
    v_mov_b32 v11, 50000
    v_or_b32 v9, 0x00ffffff, v10
    v_cmp_gt_u32_sdwa vcc, v11, v8 src0_sel:DWORD src1_sel:WORD_0
    s_nop 1
    v_cndmask_b32 v20, v9, v20, vcc
    v_cndmask_b32 v21, v9, v21, vcc
    v_cndmask_b32 v22, v9, v22, vcc
    v_cndmask_b32 v23, v9, v23, vcc
    s_branch K_PS_LOOP
K_PS_OK:
    v_cmpx_eq_u32 vcc, 1, v8
    s_cbranch_execz K_PS_X
    v_lshrrev_b32 v9, 2, v0
    ds_write_b8 v9, v12 offset:61968
    s_mov_b32 s55, 2
K_PS_X:
    s_mov_b64 exec, -1
    s_branch K_BUILD
K_PEND0:
    s_or_b32 s55, s55, 1
K_SETFLAG0:
    v_mov_b32 v8, s55
    ds_or_b32 v15, v8 offset:60668
    s_branch K_FLAG_RET0
K_PENDG:
    s_or_b32 s55, s55, 1
K_SETFLAGG:
    v_mov_b32 v8, s55
    ds_or_b32 v15, v8 offset:60668
    s_branch K_FLAG_RETG
K_SPILL:
    v_mov_b32 v10, 0x00ffffff
    s_cmp_lg_u32 s56, 0
    s_cbranch_scc1 K_SPILL_G
    v_cmp_le_u32 vcc, 39, v40
    s_nop 1
    v_cndmask_b32 v16, v10, v16, vcc
    v_cmp_le_u32 vcc, 39, v41
    s_nop 1
    v_cndmask_b32 v17, v10, v17, vcc
    v_cmp_le_u32 vcc, 39, v42
    s_nop 1
    v_cndmask_b32 v18, v10, v18, vcc
    v_cmp_le_u32 vcc, 39, v43
    s_nop 1
    v_cndmask_b32 v19, v10, v19, vcc
    v_cmp_le_u32 vcc, 39, v44
    s_nop 1
    v_cndmask_b32 v20, v10, v20, vcc
    v_cmp_le_u32 vcc, 39, v45
    s_nop 1
    v_cndmask_b32 v21, v10, v21, vcc
    v_cmp_le_u32 vcc, 39, v46
    s_nop 1
    v_cndmask_b32 v22, v10, v22, vcc
    v_cmp_le_u32 vcc, 39, v47
    s_nop 1
    v_cndmask_b32 v23, v10, v23, vcc
    s_branch K_SPILL_S
K_SPILL_G:
    v_cmp_le_u32 vcc, 39, v72
    s_nop 1
    v_cndmask_b32 v16, v10, v16, vcc
    v_cmp_le_u32 vcc, 39, v73
    s_nop 1
    v_cndmask_b32 v17, v10, v17, vcc
    v_cmp_le_u32 vcc, 39, v74
    s_nop 1
    v_cndmask_b32 v18, v10, v18, vcc
    v_cmp_le_u32 vcc, 39, v75
    s_nop 1
    v_cndmask_b32 v19, v10, v19, vcc
    v_cmp_le_u32 vcc, 39, v76
    s_nop 1
    v_cndmask_b32 v20, v10, v20, vcc
    v_cmp_le_u32 vcc, 39, v77
    s_nop 1
    v_cndmask_b32 v21, v10, v21, vcc
    v_cmp_le_u32 vcc, 39, v78
    s_nop 1
    v_cndmask_b32 v22, v10, v22, vcc
    v_cmp_le_u32 vcc, 39, v79
    s_nop 1
    v_cndmask_b32 v23, v10, v23, vcc
K_SPILL_S:
    v_lshlrev_b32 v10, 4, v0
    s_lshl_b32 s30, s2, 15
    s_add_u32 s30, s30, 16777216
    v_add_u32 v10, s30, v10
    v_add_u32 v11, 16384, v10
    global_store_dwordx4 v10, v[16:19], s[28:29] sc1
    global_store_dwordx4 v11, v[20:23], s[28:29] sc1
    s_waitcnt vmcnt(0)
    s_branch K_SPILL_RET
K_RARE:
    s_barrier
    s_add_u32 s56, s56, 1
    s_cmp_eq_u32 s56, 1
    s_cbranch_scc0 K_R1
    s_and_b32 s57, s55, 2
    ds_read_u8 v64, v1 offset:61968
    ds_read_u8 v65, v1 offset:62032
    ds_read_u8 v66, v1 offset:62096
    ds_read_u8 v67, v1 offset:62160
    s_waitcnt lgkmcnt(0)
    v_cmp_ne_u32 s[72:73], 0, v64
    v_cmp_ne_u32 s[74:75], 0, v65
    v_cmp_ne_u32 s[76:77], 0, v66
    v_cmp_ne_u32 s[78:79], 0, v67
K_R1:
    s_and_b32 s30, s55, 1
    s_cbranch_scc0 K_RNEXT
    v_lshlrev_b32 v10, 4, v0
    s_lshl_b32 s30, s2, 15
    s_add_u32 s30, s30, 16777216
    v_add_u32 v10, s30, v10
    v_add_u32 v11, 16384, v10
    global_load_dwordx4 v[16:19], v10, s[28:29] sc1
    global_load_dwordx4 v[20:23], v11, s[28:29] sc1
    s_branch K_RINIT
K_RNEXT:
    s_cmp_lg_u64 s[72:73], 0
    s_cbranch_scc1 K_RQ0
    s_cmp_lg_u64 s[74:75], 0
    s_cbranch_scc1 K_RQ1
    s_cmp_lg_u64 s[76:77], 0
    s_cbranch_scc1 K_RQ2
    s_cmp_lg_u64 s[78:79], 0
    s_cbranch_scc1 K_RQ3
    s_branch K_EPI
K_RQ0:
    s_ff1_i32_b64 s64, s[72:73]
    s_bitset0_b64 s[72:73], s64
    s_add_u32 s64, s64, 0
    s_branch K_RGOT
K_RQ1:
    s_ff1_i32_b64 s64, s[74:75]
    s_bitset0_b64 s[74:75], s64
    s_add_u32 s64, s64, 64
    s_branch K_RGOT
K_RQ2:
    s_ff1_i32_b64 s64, s[76:77]
    s_bitset0_b64 s[76:77], s64
    s_add_u32 s64, s64, 128
    s_branch K_RGOT
K_RQ3:
    s_ff1_i32_b64 s64, s[78:79]
    s_bitset0_b64 s[78:79], s64
    s_add_u32 s64, s64, 192
    s_branch K_RGOT
K_RGOT:
    s_lshl_b32 s30, s64, 2
    s_add_u32 s30, s30, 4096
    v_mov_b32 v10, s30
    s_mov_b32 s62, 0
K_RHDR:
    global_load_dword v11, v10, s[28:29] sc1
    s_waitcnt vmcnt(0)
    v_lshrrev_b32 v8, 24, v11
    s_nop 0
    v_readfirstlane_b32 s30, v8
    s_add_u32 s62, s62, 1
    s_cmp_eq_u32 s30, s49
    s_cbranch_scc1 K_RHDR_OK
    s_cmp_lt_u32 s62, 200000
    s_cbranch_scc1 K_RHDR
K_RHDR_OK:
    s_mul_i32 s30, s64, 12544
    s_add_u32 s30, s30, 8454144
    v_lshlrev_b32 v10, 2, v0
    v_add_u32 v10, s30, v10
    global_load_dword v16, v10, s[28:29] sc1
    v_add_u32 v10, 4096, v10
    global_load_dword v17, v10, s[28:29] sc1
    v_add_u32 v10, 4096, v10
    global_load_dword v18, v10, s[28:29] sc1
    v_add_u32 v10, 4096, v10
    global_load_dword v19, v10, s[28:29] sc1
    s_waitcnt vmcnt(0)
    v_and_b32 v11, 0xffffff, v11
    v_mov_b32 v9, 0x00ffffff
    v_add_u32 v8, 0, v0
    v_cmp_lt_u32 vcc, v8, v11
    v_lshrrev_b32 v8, 24, v16
    v_cmp_eq_u32 s[30:31], s2, v8
    s_and_b64 vcc, vcc, s[30:31]
    s_nop 0
    v_cndmask_b32 v16, v9, v16, vcc
    v_add_u32 v8, 1024, v0
    v_cmp_lt_u32 vcc, v8, v11
    v_lshrrev_b32 v8, 24, v17
    v_cmp_eq_u32 s[30:31], s2, v8
    s_and_b64 vcc, vcc, s[30:31]
    s_nop 0
    v_cndmask_b32 v17, v9, v17, vcc
    v_add_u32 v8, 2048, v0
    v_cmp_lt_u32 vcc, v8, v11
    v_lshrrev_b32 v8, 24, v18
    v_cmp_eq_u32 s[30:31], s2, v8
    s_and_b64 vcc, vcc, s[30:31]
    s_nop 0
    v_cndmask_b32 v18, v9, v18, vcc
    v_add_u32 v8, 3072, v0
    v_cmp_lt_u32 vcc, v8, v11
    v_lshrrev_b32 v8, 24, v19
    v_cmp_eq_u32 s[30:31], s2, v8
    s_and_b64 vcc, vcc, s[30:31]
    s_nop 0
    v_cndmask_b32 v19, v9, v19, vcc
    v_mov_b32 v20, v9
    v_mov_b32 v21, v9
    v_mov_b32 v22, v9
    v_mov_b32 v23, v9
K_RINIT:
    v_lshlrev_b32 v11, 2, v0
    v_cmpx_gt_u32 vcc, 256, v0
    ds_write_b32 v11, v15 offset:59648
    s_mov_b64 exec, -1
    s_mov_b32 s55, 0
    s_waitcnt vmcnt(0) lgkmcnt(0)
    s_barrier
    v_mov_b32 v11, 50000
    v_lshlrev_b32_sdwa v64, 2, v16 dst_sel:DWORD dst_unused:UNUSED_PAD src0_sel:DWORD src1_sel:BYTE_2
    v_mov_b32 v72, 0
    v_lshlrev_b32_sdwa v65, 2, v17 dst_sel:DWORD dst_unused:UNUSED_PAD src0_sel:DWORD src1_sel:BYTE_2
    v_mov_b32 v73, 0
    v_lshlrev_b32_sdwa v66, 2, v18 dst_sel:DWORD dst_unused:UNUSED_PAD src0_sel:DWORD src1_sel:BYTE_2
    v_mov_b32 v74, 0
    v_lshlrev_b32_sdwa v67, 2, v19 dst_sel:DWORD dst_unused:UNUSED_PAD src0_sel:DWORD src1_sel:BYTE_2
    v_mov_b32 v75, 0
    v_lshlrev_b32_sdwa v68, 2, v20 dst_sel:DWORD dst_unused:UNUSED_PAD src0_sel:DWORD src1_sel:BYTE_2
    v_mov_b32 v76, 0
    v_lshlrev_b32_sdwa v69, 2, v21 dst_sel:DWORD dst_unused:UNUSED_PAD src0_sel:DWORD src1_sel:BYTE_2
    v_mov_b32 v77, 0
    v_lshlrev_b32_sdwa v70, 2, v22 dst_sel:DWORD dst_unused:UNUSED_PAD src0_sel:DWORD src1_sel:BYTE_2
    v_mov_b32 v78, 0
    v_lshlrev_b32_sdwa v71, 2, v23 dst_sel:DWORD dst_unused:UNUSED_PAD src0_sel:DWORD src1_sel:BYTE_2
    v_mov_b32 v79, 0
    s_mov_b64 exec, -1
    v_cmpx_gt_u32_sdwa vcc, v11, v16 src0_sel:DWORD src1_sel:WORD_0
    ds_add_rtn_u32 v72, v64, v12 offset:59648
    s_mov_b64 exec, -1
    v_cmpx_gt_u32_sdwa vcc, v11, v17 src0_sel:DWORD src1_sel:WORD_0
    ds_add_rtn_u32 v73, v65, v12 offset:59648
    s_mov_b64 exec, -1
    v_cmpx_gt_u32_sdwa vcc, v11, v18 src0_sel:DWORD src1_sel:WORD_0
    ds_add_rtn_u32 v74, v66, v12 offset:59648
    s_mov_b64 exec, -1
    v_cmpx_gt_u32_sdwa vcc, v11, v19 src0_sel:DWORD src1_sel:WORD_0
    ds_add_rtn_u32 v75, v67, v12 offset:59648
    s_mov_b64 exec, -1
    v_cmpx_gt_u32_sdwa vcc, v11, v20 src0_sel:DWORD src1_sel:WORD_0
    ds_add_rtn_u32 v76, v68, v12 offset:59648
    s_mov_b64 exec, -1
    v_cmpx_gt_u32_sdwa vcc, v11, v21 src0_sel:DWORD src1_sel:WORD_0
    ds_add_rtn_u32 v77, v69, v12 offset:59648
    s_mov_b64 exec, -1
    v_cmpx_gt_u32_sdwa vcc, v11, v22 src0_sel:DWORD src1_sel:WORD_0
    ds_add_rtn_u32 v78, v70, v12 offset:59648
    s_mov_b64 exec, -1
    v_cmpx_gt_u32_sdwa vcc, v11, v23 src0_sel:DWORD src1_sel:WORD_0
    ds_add_rtn_u32 v79, v71, v12 offset:59648
K_BG_A:
    s_mov_b64 exec, -1
    s_waitcnt lgkmcnt(0)
    s_mov_b64 exec, -1
    v_cmpx_gt_u32_sdwa vcc, v11, v16 src0_sel:DWORD src1_sel:WORD_0
    v_min_u32 v9, 39, v72
    v_lshlrev_b32 v9, 1, v9
    v_mad_u32_u24 v9, v64, 20, v9
    ds_write_b16 v9, v16 offset:0
    s_mov_b64 exec, -1
    v_cmpx_gt_u32_sdwa vcc, v11, v17 src0_sel:DWORD src1_sel:WORD_0
    v_min_u32 v9, 39, v73
    v_lshlrev_b32 v9, 1, v9
    v_mad_u32_u24 v9, v65, 20, v9
    ds_write_b16 v9, v17 offset:0
    s_mov_b64 exec, -1
    v_cmpx_gt_u32_sdwa vcc, v11, v18 src0_sel:DWORD src1_sel:WORD_0
    v_min_u32 v9, 39, v74
    v_lshlrev_b32 v9, 1, v9
    v_mad_u32_u24 v9, v66, 20, v9
    ds_write_b16 v9, v18 offset:0
    s_mov_b64 exec, -1
    v_cmpx_gt_u32_sdwa vcc, v11, v19 src0_sel:DWORD src1_sel:WORD_0
    v_min_u32 v9, 39, v75
    v_lshlrev_b32 v9, 1, v9
    v_mad_u32_u24 v9, v67, 20, v9
    ds_write_b16 v9, v19 offset:0
    s_mov_b64 exec, -1
    v_cmpx_gt_u32_sdwa vcc, v11, v20 src0_sel:DWORD src1_sel:WORD_0
    v_min_u32 v9, 39, v76
    v_lshlrev_b32 v9, 1, v9
    v_mad_u32_u24 v9, v68, 20, v9
    ds_write_b16 v9, v20 offset:0
    s_mov_b64 exec, -1
    v_cmpx_gt_u32_sdwa vcc, v11, v21 src0_sel:DWORD src1_sel:WORD_0
    v_min_u32 v9, 39, v77
    v_lshlrev_b32 v9, 1, v9
    v_mad_u32_u24 v9, v69, 20, v9
    ds_write_b16 v9, v21 offset:0
    s_mov_b64 exec, -1
    v_cmpx_gt_u32_sdwa vcc, v11, v22 src0_sel:DWORD src1_sel:WORD_0
    v_min_u32 v9, 39, v78
    v_lshlrev_b32 v9, 1, v9
    v_mad_u32_u24 v9, v70, 20, v9
    ds_write_b16 v9, v22 offset:0
    s_mov_b64 exec, -1
    v_cmpx_gt_u32_sdwa vcc, v11, v23 src0_sel:DWORD src1_sel:WORD_0
    v_min_u32 v9, 39, v79
    v_lshlrev_b32 v9, 1, v9
    v_mad_u32_u24 v9, v71, 20, v9
    ds_write_b16 v9, v23 offset:0
K_BG_B:
    s_mov_b64 exec, -1
    v_max3_u32 v8, v72, v73, v74
    v_max3_u32 v9, v75, v76, v77
    v_max3_u32 v8, v8, v78, v79
    v_max_u32 v8, v8, v9
    v_cmp_le_u32 vcc, 39, v8
    s_cbranch_vccnz K_PENDG
    s_cmp_lg_u32 s55, 0
    s_cbranch_scc1 K_SETFLAGG
K_FLAG_RETG:
    s_waitcnt lgkmcnt(0)
    s_barrier
    s_branch K_MAIN
.section .rodata,"a"
.p2align 6
.amdhsa_kernel standalone__hybrid_graph_tf_exphormer__graph_kernel
  .amdhsa_next_free_vgpr 128
  .amdhsa_next_free_sgpr 102
  .amdhsa_accum_offset 128
  .amdhsa_group_segment_fixed_size 0
  .amdhsa_kernarg_size 104
  .amdhsa_user_sgpr_count 2
  .amdhsa_user_sgpr_kernarg_segment_ptr 1
  .amdhsa_system_sgpr_workgroup_id_x 1
.end_amdhsa_kernel
```
